```python
import torch

def _softmax(x, axis=-1):
    return torch.softmax(x, dim=axis)
def _gelu(x):
    return torch.nn.functional.gelu(x, approximate="tanh")
def _silu(x):
    return torch.nn.functional.silu(x)
def _sigmoid(x):
    return torch.sigmoid(x)
def _layernorm(x, axis=-1, eps=1e-5):
    m = x.mean(dim=axis, keepdim=True)
    v = x.var(dim=axis, keepdim=True, unbiased=False)
    return (x - m) / torch.sqrt(v + eps)
def _scatter_add(tgt, idx, src, axis=0):
    return tgt.clone().index_add_(axis, idx, src)
def _segment_sum(src, seg, n):
    out = torch.zeros((n,) + src.shape[1:], dtype=src.dtype)
    return out.index_add_(0, seg, src)
def _pad(x, pw):
    flat = tuple(v for pair in reversed(pw) for v in pair)
    return torch.nn.functional.pad(x, flat)

kernel_name = 'recurrent_scan__ssm_conv_h3__glu_gated_geglu__prompt'

def setup_inputs():

    _w = (lambda a: (lambda t: t.to(torch.bfloat16) if t.is_floating_point() else t)(torch.as_tensor(a)))
    def _A_setup():
        B, S, D = 1, 2048, 448
        ks = 4
        return {
            "q": _w((lambda *s: torch.randn(*s, dtype=torch.bfloat16) * 0.05)(B, S, D)),
            "k": _w((lambda *s: torch.randn(*s, dtype=torch.bfloat16) * 0.8)(B, S, D)),
            "v": _w((lambda *s: torch.randn(*s, dtype=torch.bfloat16) * 0.8)(B, S, D)),
            "shift_k": _w((lambda *s: torch.randn(*s, dtype=torch.bfloat16) * 0.8)(D, ks) * 0.5),
            "ssm_k": _w((lambda *s: torch.randn(*s, dtype=torch.bfloat16) * 1.6)(D, S) * (1.0 / S ** 0.5)),
            "ssm_D": _w((lambda *s: torch.randn(*s, dtype=torch.bfloat16) * 0.8)(D)),
        }
    _A_in = _A_setup()

    def _B_setup():
        B, S, Dm, Df = 1, 2048, 448, 1792
        return {
            "x": _w((lambda *s: torch.randn(*s, dtype=torch.bfloat16) * 0.05)(B, S, Dm)),
            "w_gate": _w((lambda *s: torch.randn(*s, dtype=torch.bfloat16) * 0.2)(Dm, Df) * (Dm ** -0.5)),
            "w_up": _w((lambda *s: torch.randn(*s, dtype=torch.bfloat16) * 0.2)(Dm, Df) * (Dm ** -0.5)),
            "w_down": _w((lambda *s: torch.randn(*s, dtype=torch.bfloat16) * 0.2)(Df, Dm) * (Df ** -0.5)),
        }
    _B_in = _B_setup()

    return {
        "A_q": _A_in["q"],
        "A_k": _A_in["k"],
        "A_v": _A_in["v"],
        "A_shift_k": _A_in["shift_k"],
        "A_ssm_k": _A_in["ssm_k"],
        "A_ssm_D": _A_in["ssm_D"],
        "B_x": _B_in["x"],
        "B_w_gate": _B_in["w_gate"],
        "B_w_up": _B_in["w_up"],
        "B_w_down": _B_in["w_down"],
    }

def reference(A_q, A_k, A_v, A_shift_k, A_ssm_k, A_ssm_D, B_x, B_w_gate, B_w_up, B_w_down):
    def _A_ref(q, k, v, shift_k, ssm_k, ssm_D):
        B, S, D = q.shape
        ks = shift_k.shape[-1]
        k_pad = _pad(k, ((0, 0), (ks - 1, 0), (0, 0)))
        k_shift = torch.zeros_like(k)
        for t in range(ks):
            k_shift = k_shift + k_pad[:, t:t + S, :] * shift_k[:, ks - 1 - t][None, None, :]
        kv = k_shift * v
        L = 2 * S
        kv_pad = _pad(kv, ((0, 0), (0, S), (0, 0)))
        kf_pad = _pad(ssm_k, ((0, 0), (0, S)))
        kv_f = (lambda x, axes=(-2,-1): torch.fft.rfft2(x.float(), dim=axes))(kv_pad[:, None, :, :], axes=(1, 2))
        kf_f = (lambda x, axes=(-2,-1): torch.fft.rfft2(x.float(), dim=axes))(kf_pad[:, None, :], axes=(1, 2))
        kf_f = (lambda x, *d: x.permute(*d))(kf_f, 1, 2, 0)
        y_f = kv_f * kf_f[None, :, :, :]
        y = (lambda x, s, axes=(-2,-1): torch.fft.irfft2(x, s=s, dim=axes).to(torch.bfloat16))(y_f, (1, L), axes=(1, 2))[:, 0, :S, :]
        y = y + kv * ssm_D[None, None, :]
        return q * y

    def _B_ref(x, w_gate, w_up, w_down):
        g = torch.einsum("bsd,df->bsf", x, w_gate)
        u = torch.einsum("bsd,df->bsf", x, w_up)
        h = _gelu(g) * u
        return torch.einsum("bsf,fd->bsd", h, w_down)

    x = A_q
    xn = _layernorm(x, axis=-1)
    s = _A_ref(xn, A_k, A_v, A_shift_k, A_ssm_k, A_ssm_D)
    g = _silu(_B_ref(xn, B_w_gate, B_w_up, B_w_down))
    return x + s * g
```

```asm
; @launch grid=(256,1,1) block=(256,1,1) lds=163840
.amdgcn_target "amdgcn-amd-amdhsa--gfx950"
.text
.globl recurrent_scan__ssm_conv_h3__glu_gated_geglu__prompt_kernel
.p2align 8
.type recurrent_scan__ssm_conv_h3__glu_gated_geglu__prompt_kernel,@function
recurrent_scan__ssm_conv_h3__glu_gated_geglu__prompt_kernel:
    s_cmp_ge_u32 s2, 256
    s_cbranch_scc1 L_exit
    s_load_dwordx16 s[4:19], s[0:1], 0
    s_load_dwordx8 s[20:27], s[0:1], 64
    s_load_dwordx2 s[28:29], s[0:1], 96
    v_and_b32 v1, 63, v0
    v_lshrrev_b32 v2, 6, v0
    s_nop 0
    v_readfirstlane_b32 s88, v2
    s_cmp_ge_u32 s2, 224
    s_cbranch_scc1 L_helper
    s_and_b32 s95, s2, 7
    s_lshr_b32 s96, s2, 3
    s_and_b32 s93, s96, 3
    s_lshr_b32 s94, s96, 2
    s_lshr_b32 s90, s95, 1
    s_lshl2_add_u32 s90, s90, s93
    s_and_b32 s91, s95, 1
    s_mul_i32 s91, s91, 7
    s_add_u32 s91, s91, s94
    s_mov_b32 s60, 0
    s_mov_b32 s67, 0
    s_lshl_b32 s89, s88, 12
    v_lshrrev_b32 v44, 3, v1
    v_and_b32 v45, 7, v1
    v_lshrrev_b32 v46, 4, v1
    s_lshl2_add_u32 s96, s90, s88
    s_mul_i32 s96, s96, 28672
    v_mul_u32_u24 v47, 896, v44
    v_add_u32 v47, s96, v47
    v_xor_b32 v48, v45, v46
    v_lshl_add_u32 v2, v48, 4, v47
    v_add_u32 v3, 6144, v2
    v_xor_b32 v3, 64, v3
    v_add_u32 v4, 12288, v2
    v_add_u32 v5, 12288, v3
    s_and_b32 s97, s88, 1
    s_mul_i32 s96, s97, 114688
    s_lshl_b32 s95, s91, 8
    s_add_u32 s96, s96, s95
    v_mul_u32_u24 v47, 3584, v44
    v_add_u32 v47, s96, v47
    s_and_b32 s95, s88, 2
    v_and_b32 v48, 1, v46
    v_or_b32 v48, s95, v48
    v_lshlrev_b32 v48, 1, v48
    v_xor_b32 v48, v45, v48
    v_lshl_add_u32 v6, v48, 4, v47
    v_add_u32 v7, 27648, v6
    v_add_u32 v8, 55296, v6
    v_add_u32 v9, 82944, v6
    s_mov_b32 s34, 1835008
    s_mov_b32 s35, 0x20000
    s_mov_b32 s38, 1605632
    s_mov_b32 s39, 0x20000
    s_mov_b32 m0, s89
    s_cmp_ge_u32 s88, 2
    s_waitcnt lgkmcnt(0)
    s_mov_b32 s32, s4
    s_mov_b32 s33, s5
    s_cselect_b32 s36, s20, s18
    s_cselect_b32 s37, s21, s19
    buffer_load_dwordx4 v2, s[32:35], s60 offen offset:0 lds
    buffer_load_dwordx4 v3, s[32:35], s60 offen offset:1024 lds
    buffer_load_dwordx4 v4, s[32:35], s60 offen offset:2048 lds
    buffer_load_dwordx4 v5, s[32:35], s60 offen offset:3072 lds
    s_add_u32 m0, s89, 16384
    s_nop 0
    buffer_load_dwordx4 v6, s[36:39], s67 offen offset:0 lds
    buffer_load_dwordx4 v7, s[36:39], s67 offen offset:1024 lds
    buffer_load_dwordx4 v8, s[36:39], s67 offen offset:2048 lds
    buffer_load_dwordx4 v9, s[36:39], s67 offen offset:3072 lds
    s_add_u32 s96, s93, s94
    s_mul_i32 s92, s96, 11
    s_lshr_b32 s92, s92, 5
    s_mul_i32 s92, s92, 3
    s_sub_u32 s92, s96, s92
    s_add_u32 s96, s92, 1
    s_lshl_b32 s61, s96, 7
    s_mul_i32 s68, s96, 229376
    s_add_u32 m0, s89, 32768
    s_nop 0
    buffer_load_dwordx4 v2, s[32:35], s61 offen offset:0 lds
    s_add_u32 s92, s92, 1
    s_cmp_eq_u32 s92, 3
    s_cselect_b32 s92, 0, s92
    s_add_u32 s96, s92, 1
    s_lshl_b32 s62, s96, 7
    s_mul_i32 s69, s96, 229376
    s_add_u32 s92, s92, 1
    s_cmp_eq_u32 s92, 3
    s_cselect_b32 s92, 0, s92
    s_add_u32 s96, s92, 1
    s_lshl_b32 s63, s96, 7
    s_mul_i32 s70, s96, 229376
    s_add_u32 s92, s92, 1
    s_cmp_eq_u32 s92, 3
    s_cselect_b32 s92, 0, s92
    buffer_load_dwordx4 v3, s[32:35], s61 offen offset:1024 lds
    s_add_u32 s96, s92, 4
    s_lshl_b32 s64, s96, 7
    s_mul_i32 s71, s96, 229376
    s_add_u32 s92, s92, 1
    s_cmp_eq_u32 s92, 3
    s_cselect_b32 s92, 0, s92
    s_add_u32 s96, s92, 4
    s_lshl_b32 s65, s96, 7
    s_mul_i32 s72, s96, 229376
    s_add_u32 s92, s92, 1
    s_cmp_eq_u32 s92, 3
    s_cselect_b32 s92, 0, s92
    s_add_u32 s96, s92, 4
    s_lshl_b32 s66, s96, 7
    buffer_load_dwordx4 v4, s[32:35], s61 offen offset:2048 lds
    s_mul_i32 s73, s96, 229376
    s_lshr_b32 s98, s88, 1
    v_and_b32 v47, 31, v1
    v_lshrrev_b32 v48, 5, v1
    v_bfe_u32 v49, v1, 1, 3
    v_xor_b32 v49, v49, v48
    v_lshlrev_b32 v49, 4, v49
    v_lshl_add_u32 v49, v47, 7, v49
    s_lshl1_add_u32 s95, s97, s98
    s_lshl_b32 s95, s95, 12
    v_add_u32 v68, s95, v49
    v_xor_b32 v69, 32, v68
    v_xor_b32 v70, 64, v68
    v_xor_b32 v71, 96, v68
    buffer_load_dwordx4 v5, s[32:35], s61 offen offset:3072 lds
    v_xor_b32 v72, 4096, v68
    v_xor_b32 v73, 4096, v69
    v_xor_b32 v74, 4096, v70
    v_xor_b32 v75, 4096, v71
    v_or_b32 v76, 0x10000, v68
    v_or_b32 v77, 0x10000, v69
    v_or_b32 v78, 0x10000, v70
    v_or_b32 v79, 0x10000, v71
    v_or_b32 v80, 0x10000, v72
    v_or_b32 v81, 0x10000, v73
    v_or_b32 v82, 0x10000, v74
    v_or_b32 v83, 0x10000, v75
    v_bfe_u32 v50, v1, 2, 2
    v_lshl_add_u32 v51, v48, 3, v50
    s_add_u32 m0, s89, 49152
    s_nop 0
    buffer_load_dwordx4 v6, s[36:39], s68 offen offset:0 lds
    v_lshlrev_b32 v51, 7, v51
    v_bfe_u32 v52, v1, 4, 1
    v_and_b32 v53, 1, v1
    v_bfe_u32 v54, v1, 1, 1
    v_bfe_u32 v55, v1, 3, 1
    v_lshl_add_u32 v56, v54, 13, v51
    v_lshl_add_u32 v56, v53, 4, v56
    v_lshl_add_u32 v56, v52, 3, v56
    v_lshl_add_u32 v57, v54, 1, v55
    v_xor_b32 v57, s88, v57
    v_lshl_add_u32 v30, v57, 5, v56
    v_xor_b32 v31, 32, v30
    v_or_b32 v32, 0x10000, v30
    v_or_b32 v33, 0x10000, v31
    buffer_load_dwordx4 v7, s[36:39], s68 offen offset:1024 lds
    v_and_b32 v57, 7, v1
    v_lshlrev_b32 v58, 2, v52
    v_cmp_eq_u32 vcc, v57, v58
    v_mov_b32 v57, 0x3f803f80
    s_nop 0
    v_cndmask_b32 v92, 0, v57, vcc
    v_cndmask_b32 v93, 0, v57, vcc
    v_cndmask_b32 v94, 0, v57, vcc
    v_cndmask_b32 v95, 0, v57, vcc
    s_lshl_b32 s95, s2, 2
    s_load_dword s99, s[14:15], s95
    buffer_load_dwordx4 v8, s[36:39], s68 offen offset:2048 lds
    buffer_load_dwordx4 v9, s[36:39], s68 offen offset:3072 lds
    s_waitcnt lgkmcnt(0)
    s_waitcnt vmcnt(8)
    s_barrier
    ds_read_b128 a[0:3], v68 offset:0
    ds_read_b64_tr_b16 v[112:113], v30 offset:16384
    ds_read_b64_tr_b16 v[114:115], v30 offset:16896
    ds_read_b128 a[4:7], v72 offset:0
    ds_read_b64_tr_b16 v[116:117], v31 offset:16384
    ds_read_b64_tr_b16 v[118:119], v31 offset:16896
    s_waitcnt lgkmcnt(3)
    v_mfma_f32_32x32x16_bf16 v[128:143], v[112:115], a[0:3], 0
    s_add_u32 m0, s89, 65536
    s_and_b32 s95, s2, 7
    buffer_load_dwordx4 v2, s[32:35], s62 offen offset:0 lds
    ds_read_b128 a[8:11], v69 offset:0
    ds_read_b64_tr_b16 v[120:121], v30 offset:18432
    ds_read_b64_tr_b16 v[122:123], v30 offset:18944
    s_waitcnt lgkmcnt(5)
    v_mfma_f32_32x32x16_bf16 v[144:159], v[112:115], a[4:7], 0
    ds_read_b128 a[12:15], v73 offset:0
    ds_read_b64_tr_b16 v[124:125], v31 offset:18432
    ds_read_b64_tr_b16 v[126:127], v31 offset:18944
    s_waitcnt lgkmcnt(6)
    v_mfma_f32_32x32x16_bf16 v[160:175], v[116:119], a[0:3], 0
    buffer_load_dwordx4 v3, s[32:35], s62 offen offset:1024 lds
    v_mfma_f32_32x32x16_bf16 v[176:191], v[116:119], a[4:7], 0
    buffer_load_dwordx4 v4, s[32:35], s62 offen offset:2048 lds
    v_mfma_f32_4x4x4_16b_bf16 v[100:103], a[0:1], a[0:1], 0
    v_mfma_f32_4x4x4_16b_bf16 v[88:91], a[2:3], a[2:3], 0
    v_mfma_f32_16x16x32_bf16 v[96:99], v[92:95], a[0:3], 0
    v_mfma_f32_16x16x32_bf16 v[104:107], v[92:95], v[112:115], 0
    s_waitcnt lgkmcnt(0)
    v_mfma_f32_32x32x16_bf16 v[128:143], v[120:123], a[8:11], v[128:143]
    buffer_load_dwordx4 v5, s[32:35], s62 offen offset:3072 lds
    ds_read_b128 a[16:19], v70 offset:0
    ds_read_b64_tr_b16 v[112:113], v30 offset:20480
    ds_read_b64_tr_b16 v[114:115], v30 offset:20992
    v_mfma_f32_32x32x16_bf16 v[144:159], v[120:123], a[12:15], v[144:159]
    ds_read_b128 a[20:23], v74 offset:0
    ds_read_b64_tr_b16 v[116:117], v31 offset:20480
    ds_read_b64_tr_b16 v[118:119], v31 offset:20992
    v_mfma_f32_32x32x16_bf16 v[160:175], v[124:127], a[8:11], v[160:175]
    s_add_u32 m0, s89, 81920
    s_lshl2_add_u32 s10, s95, s93
    buffer_load_dwordx4 v6, s[36:39], s69 offen offset:0 lds
    v_mfma_f32_32x32x16_bf16 v[176:191], v[124:127], a[12:15], v[176:191]
    buffer_load_dwordx4 v7, s[36:39], s69 offen offset:1024 lds
    v_mfma_f32_4x4x4_16b_bf16 v[100:103], a[8:9], a[8:9], v[100:103]
    v_mfma_f32_4x4x4_16b_bf16 v[88:91], a[10:11], a[10:11], v[88:91]
    v_mfma_f32_16x16x32_bf16 v[96:99], v[92:95], a[8:11], v[96:99]
    v_mfma_f32_16x16x32_bf16 v[104:107], v[92:95], v[120:123], v[104:107]
    s_waitcnt lgkmcnt(0)
    v_mfma_f32_32x32x16_bf16 v[128:143], v[112:115], a[16:19], v[128:143]
    buffer_load_dwordx4 v8, s[36:39], s69 offen offset:2048 lds
    ds_read_b128 a[24:27], v71 offset:0
    ds_read_b64_tr_b16 v[120:121], v30 offset:22528
    ds_read_b64_tr_b16 v[122:123], v30 offset:23040
    v_mfma_f32_32x32x16_bf16 v[144:159], v[112:115], a[20:23], v[144:159]
    ds_read_b128 a[28:31], v75 offset:0
    ds_read_b64_tr_b16 v[124:125], v31 offset:22528
    ds_read_b64_tr_b16 v[126:127], v31 offset:23040
    v_mfma_f32_32x32x16_bf16 v[160:175], v[116:119], a[16:19], v[160:175]
    buffer_load_dwordx4 v9, s[36:39], s69 offen offset:3072 lds
    v_mfma_f32_32x32x16_bf16 v[176:191], v[116:119], a[20:23], v[176:191]
    s_add_u32 m0, s89, 98304
    s_mov_b32 s11, s94
    buffer_load_dwordx4 v2, s[32:35], s63 offen offset:0 lds
    v_mfma_f32_4x4x4_16b_bf16 v[100:103], a[16:17], a[16:17], v[100:103]
    v_mfma_f32_4x4x4_16b_bf16 v[88:91], a[18:19], a[18:19], v[88:91]
    v_mfma_f32_16x16x32_bf16 v[96:99], v[92:95], a[16:19], v[96:99]
    v_mfma_f32_16x16x32_bf16 v[104:107], v[92:95], v[112:115], v[104:107]
    s_waitcnt lgkmcnt(0)
    v_mfma_f32_32x32x16_bf16 v[128:143], v[120:123], a[24:27], v[128:143]
    s_waitcnt vmcnt(9)
    s_barrier
    s_mov_b32 s40, s22
    s_mov_b32 s41, s23
    s_mov_b32 s42, 1605632
    s_mov_b32 s43, 0x20000
    s_mov_b32 s44, s28
    s_mov_b32 s45, s29
    s_mov_b32 s46, 15728640
    s_mov_b32 s47, 0x20000
    s_mov_b32 s48, s12
    s_mov_b32 s49, s13
    s_mov_b32 s50, 1835008
    s_mov_b32 s51, 0x20000
    s_mov_b32 s52, s24
    s_mov_b32 s53, s25
    s_mov_b32 s54, 1835008
    s_mov_b32 s55, 0x20000
    s_mov_b32 s56, s26
    s_mov_b32 s57, s27
    s_mov_b32 s58, 256
    s_mov_b32 s59, 0x20000
    s_mov_b32 s14, 4096
    v_lshl_add_u32 v56, v53, 5, v51
    v_lshl_add_u32 v56, v52, 4, v56
    v_lshl_add_u32 v56, v54, 3, v56
    v_add_u32 v56, s89, v56
    v_lshl_add_u32 v34, v55, 6, v56
    v_xor_b32 v35, 64, v34
    v_or_b32 v36, 0x10000, v34
    v_or_b32 v37, 0x10000, v35
    v_mul_u32_u24 v47, 896, v44
    s_lshl_b32 s95, s11, 7
    v_add_u32 v47, s95, v47
    v_xor_b32 v58, v45, v58
    v_lshl_add_u32 v10, v58, 4, v47
    v_add_u32 v11, 6144, v10
    v_add_u32 v12, 12288, v10
    v_add_u32 v13, 18432, v10
    s_mul_i32 s100, s10, 224
    s_mul_i32 s92, s88, 14
    s_lshl1_add_u32 s101, s93, s94
    s_and_b32 s96, s2, 7
    s_add_u32 s101, s101, s96
    s_mul_i32 s96, s101, 37
    s_lshr_b32 s96, s96, 8
    s_mul_i32 s96, s96, 7
    s_sub_u32 s101, s101, s96
    s_lshl1_add_u32 s95, s101, s92
    s_add_u32 s81, s95, s100
    s_lshl_b32 s81, s81, 10
    s_and_b32 s96, s95, 0xfc
    s_add_u32 s95, s95, s96
    s_mul_i32 s74, s95, 14336
    s_add_u32 s101, s101, 1
    s_cmp_eq_u32 s101, 7
    s_cselect_b32 s101, 0, s101
    s_lshl1_add_u32 s95, s101, s92
    s_add_u32 s82, s95, s100
    s_lshl_b32 s82, s82, 10
    s_and_b32 s96, s95, 0xfc
    s_add_u32 s95, s95, s96
    s_mul_i32 s75, s95, 14336
    s_add_u32 s101, s101, 1
    s_cmp_eq_u32 s101, 7
    s_cselect_b32 s101, 0, s101
    s_lshl1_add_u32 s95, s101, s92
    s_add_u32 s83, s95, s100
    s_lshl_b32 s83, s83, 10
    s_and_b32 s96, s95, 0xfc
    s_add_u32 s95, s95, s96
    s_mul_i32 s76, s95, 14336
    s_add_u32 s101, s101, 1
    s_cmp_eq_u32 s101, 7
    s_cselect_b32 s101, 0, s101
    s_lshl1_add_u32 s95, s101, s92
    s_add_u32 s84, s95, s100
    s_lshl_b32 s84, s84, 10
    s_and_b32 s96, s95, 0xfc
    s_add_u32 s95, s95, s96
    s_mul_i32 s77, s95, 14336
    s_add_u32 s101, s101, 1
    s_cmp_eq_u32 s101, 7
    s_cselect_b32 s101, 0, s101
    s_lshl1_add_u32 s95, s101, s92
    s_add_u32 s85, s95, s100
    s_lshl_b32 s85, s85, 10
    s_and_b32 s96, s95, 0xfc
    s_add_u32 s95, s95, s96
    s_mul_i32 s78, s95, 14336
    s_add_u32 s101, s101, 1
    s_cmp_eq_u32 s101, 7
    s_cselect_b32 s101, 0, s101
    s_lshl1_add_u32 s95, s101, s92
    s_add_u32 s86, s95, s100
    s_lshl_b32 s86, s86, 10
    s_and_b32 s96, s95, 0xfc
    s_add_u32 s95, s95, s96
    s_mul_i32 s79, s95, 14336
    s_add_u32 s101, s101, 1
    s_cmp_eq_u32 s101, 7
    s_cselect_b32 s101, 0, s101
    s_lshl1_add_u32 s95, s101, s92
    s_add_u32 s87, s95, s100
    s_lshl_b32 s87, s87, 10
    s_and_b32 s96, s95, 0xfc
    s_add_u32 s95, s95, s96
    s_mul_i32 s80, s95, 14336
    v_lshlrev_b32 v40, 4, v1
    v_add_u32 v41, 114688, v40
    v_add_u32 v42, 57344, v40
    v_add_u32 v43, 172032, v40
    s_lshl1_add_u32 s95, s97, s98
    s_lshl2_add_u32 s95, s90, s95
    s_xor_b32 s96, s95, 1
    s_mul_i32 s95, s95, 112
    s_mul_i32 s96, s96, 112
    s_lshl2_add_u32 s100, s91, s88
    s_add_u32 s6, s95, s100
    s_add_u32 s7, s96, s100
    s_xor_b32 s100, s100, 1
    s_add_u32 s8, s95, s100
    s_add_u32 s9, s96, s100
    s_lshl_b32 s6, s6, 10
    s_lshl_b32 s7, s7, 10
    s_lshl_b32 s8, s8, 10
    s_lshl_b32 s9, s9, 10
    s_mov_b32 s16, 0xaaaaaaaa
    s_mov_b32 s17, 0xaaaaaaaa
    s_mov_b32 s30, 0xcccccccc
    s_mov_b32 s31, 0xcccccccc
    s_mov_b32 s0, 0
    s_mov_b32 s1, -1
    s_lshl1_add_u32 s95, s90, s97
    s_lshl_b32 s95, s95, 5
    s_lshl1_add_u32 s96, s91, s98
    s_add_u32 s95, s95, s96
    s_lshl2_add_u32 s95, s95, 7405568
    v_mov_b32 v50, 2130706432
    v_writelane_b32 v50, s95, 0
    v_lshlrev_b32 v29, 2, v1
    v_cndmask_b32 v29, 0, v29, s[0:1]
    s_cmp_eq_u32 s88, 0
    s_cselect_b32 s4, 1, 0
    s_cselect_b32 s5, 2, 0
    s_cselect_b32 s95, 0, 2130706432
    v_add_u32 v29, s95, v29
    s_lshl1_add_u32 s95, s97, s98
    s_lshl2_add_u32 s95, s90, s95
    s_lshl_b32 s95, s95, 8
    s_add_u32 s95, s95, 7340032
    s_cmp_eq_u32 s91, 0
    s_cselect_b32 s95, s95, 2130706432
    v_lshl_add_u32 v28, v1, 3, s95
    v_mov_b32 v47, 2130706432
    v_cndmask_b32 v28, v28, v47, s[0:1]
    s_lshl2_add_u32 s101, s2, s88
    s_lshl_b32 s101, s101, 11
    s_add_u32 s101, s101, 10485760
    v_and_b32 v47, 15, v1
    v_add_u32 v56, 1, v47
    v_and_b32 v57, 1, v56
    v_mul_u32_u24 v57, 4160, v57
    v_and_b32 v56, 30, v56
    v_lshl_add_u32 v56, v46, 3, v56
    v_lshl_add_u32 v14, v56, 1, v57
    buffer_load_dwordx4 v3, s[32:35], s63 offen offset:1024 lds
    ds_read_b128 a[32:35], v68 offset:32768
    ds_read_b64_tr_b16 v[112:113], v30 offset:49152
    ds_read_b64_tr_b16 v[114:115], v30 offset:49664
    v_mfma_f32_32x32x16_bf16 v[144:159], v[120:123], a[28:31], v[144:159]
    ds_read_b128 a[36:39], v72 offset:32768
    ds_read_b64_tr_b16 v[116:117], v31 offset:49152
    ds_read_b64_tr_b16 v[118:119], v31 offset:49664
    v_mfma_f32_32x32x16_bf16 v[160:175], v[124:127], a[24:27], v[160:175]
    buffer_load_dwordx4 v4, s[32:35], s63 offen offset:2048 lds
    v_mfma_f32_32x32x16_bf16 v[176:191], v[124:127], a[28:31], v[176:191]
    buffer_load_dwordx4 v5, s[32:35], s63 offen offset:3072 lds
    v_mfma_f32_4x4x4_16b_bf16 v[100:103], a[24:25], a[24:25], v[100:103]
    v_mfma_f32_4x4x4_16b_bf16 v[88:91], a[26:27], a[26:27], v[88:91]
    v_mfma_f32_16x16x32_bf16 v[96:99], v[92:95], a[24:27], v[96:99]
    v_mfma_f32_16x16x32_bf16 v[104:107], v[92:95], v[120:123], v[104:107]
    s_waitcnt lgkmcnt(0)
    v_mfma_f32_32x32x16_bf16 v[128:143], v[112:115], a[32:35], v[128:143]
    s_add_u32 m0, s89, 114688
    s_mul_i32 s95, s98, 8320
    buffer_load_dwordx4 v6, s[36:39], s70 offen offset:0 lds
    ds_read_b128 a[40:43], v69 offset:32768
    ds_read_b64_tr_b16 v[120:121], v30 offset:51200
    ds_read_b64_tr_b16 v[122:123], v30 offset:51712
    v_mfma_f32_32x32x16_bf16 v[144:159], v[112:115], a[36:39], v[144:159]
    ds_read_b128 a[44:47], v73 offset:32768
    ds_read_b64_tr_b16 v[124:125], v31 offset:51200
    ds_read_b64_tr_b16 v[126:127], v31 offset:51712
    v_mfma_f32_32x32x16_bf16 v[160:175], v[116:119], a[32:35], v[160:175]
    buffer_load_dwordx4 v7, s[36:39], s70 offen offset:1024 lds
    v_mfma_f32_32x32x16_bf16 v[176:191], v[116:119], a[36:39], v[176:191]
    buffer_load_dwordx4 v8, s[36:39], s70 offen offset:2048 lds
    v_mfma_f32_4x4x4_16b_bf16 v[100:103], a[32:33], a[32:33], v[100:103]
    v_mfma_f32_4x4x4_16b_bf16 v[88:91], a[34:35], a[34:35], v[88:91]
    v_mfma_f32_16x16x32_bf16 v[96:99], v[92:95], a[32:35], v[96:99]
    v_mfma_f32_16x16x32_bf16 v[104:107], v[92:95], v[112:115], v[104:107]
    s_waitcnt lgkmcnt(0)
    v_mfma_f32_32x32x16_bf16 v[128:143], v[120:123], a[40:43], v[128:143]
    buffer_load_dwordx4 v9, s[36:39], s70 offen offset:3072 lds
    ds_read_b128 a[48:51], v70 offset:32768
    ds_read_b64_tr_b16 v[112:113], v30 offset:53248
    ds_read_b64_tr_b16 v[114:115], v30 offset:53760
    v_mfma_f32_32x32x16_bf16 v[144:159], v[120:123], a[44:47], v[144:159]
    ds_read_b128 a[52:55], v74 offset:32768
    ds_read_b64_tr_b16 v[116:117], v31 offset:53248
    ds_read_b64_tr_b16 v[118:119], v31 offset:53760
    v_mfma_f32_32x32x16_bf16 v[160:175], v[124:127], a[40:43], v[160:175]
    s_lshl2_add_u32 s92, s2, s88
    s_lshl_b32 s92, s92, 11
    buffer_load_dwordx4 v[192:195], v40, s[48:51], s92 offen offset:0 nt
    v_mfma_f32_32x32x16_bf16 v[176:191], v[124:127], a[44:47], v[176:191]
    buffer_load_dword v200, v40, s[48:51], s92 offen offset:16 nt
    v_mfma_f32_4x4x4_16b_bf16 v[100:103], a[40:41], a[40:41], v[100:103]
    v_mfma_f32_4x4x4_16b_bf16 v[88:91], a[42:43], a[42:43], v[88:91]
    v_mfma_f32_16x16x32_bf16 v[96:99], v[92:95], a[40:43], v[96:99]
    v_mfma_f32_16x16x32_bf16 v[104:107], v[92:95], v[120:123], v[104:107]
    s_waitcnt lgkmcnt(0)
    v_mfma_f32_32x32x16_bf16 v[128:143], v[112:115], a[48:51], v[128:143]
    buffer_load_dwordx4 v[196:199], v40, s[48:51], s92 offen offset:1024 nt
    ds_read_b128 a[56:59], v71 offset:32768
    ds_read_b64_tr_b16 v[120:121], v30 offset:55296
    ds_read_b64_tr_b16 v[122:123], v30 offset:55808
    v_mfma_f32_32x32x16_bf16 v[144:159], v[112:115], a[52:55], v[144:159]
    ds_read_b128 a[60:63], v75 offset:32768
    ds_read_b64_tr_b16 v[124:125], v31 offset:55296
    ds_read_b64_tr_b16 v[126:127], v31 offset:55808
    v_mfma_f32_32x32x16_bf16 v[160:175], v[116:119], a[48:51], v[160:175]
    buffer_load_dword v201, v40, s[48:51], s92 offen offset:1040 nt
    v_mfma_f32_32x32x16_bf16 v[176:191], v[116:119], a[52:55], v[176:191]
    s_mov_b32 m0, s89
    s_add_u32 s95, s95, 131072
    buffer_load_dwordx4 v2, s[32:35], s64 offen offset:0 lds
    v_mfma_f32_4x4x4_16b_bf16 v[100:103], a[48:49], a[48:49], v[100:103]
    v_mfma_f32_4x4x4_16b_bf16 v[88:91], a[50:51], a[50:51], v[88:91]
    v_mfma_f32_16x16x32_bf16 v[96:99], v[92:95], a[48:51], v[96:99]
    v_mfma_f32_16x16x32_bf16 v[104:107], v[92:95], v[112:115], v[104:107]
    s_waitcnt lgkmcnt(0)
    v_mfma_f32_32x32x16_bf16 v[128:143], v[120:123], a[56:59], v[128:143]
    s_waitcnt vmcnt(13)
    s_barrier
    buffer_load_dwordx4 v3, s[32:35], s64 offen offset:1024 lds
    ds_read_b128 a[64:67], v76 offset:0
    ds_read_b64_tr_b16 v[112:113], v32 offset:16384
    ds_read_b64_tr_b16 v[114:115], v32 offset:16896
    v_mfma_f32_32x32x16_bf16 v[144:159], v[120:123], a[60:63], v[144:159]
    ds_read_b128 a[68:71], v80 offset:0
    ds_read_b64_tr_b16 v[116:117], v33 offset:16384
    ds_read_b64_tr_b16 v[118:119], v33 offset:16896
    v_mfma_f32_32x32x16_bf16 v[160:175], v[124:127], a[56:59], v[160:175]
    buffer_load_dwordx4 v4, s[32:35], s64 offen offset:2048 lds
    v_mfma_f32_32x32x16_bf16 v[176:191], v[124:127], a[60:63], v[176:191]
    buffer_load_dwordx4 v5, s[32:35], s64 offen offset:3072 lds
    v_mfma_f32_4x4x4_16b_bf16 v[100:103], a[56:57], a[56:57], v[100:103]
    v_mfma_f32_4x4x4_16b_bf16 v[88:91], a[58:59], a[58:59], v[88:91]
    v_mfma_f32_16x16x32_bf16 v[96:99], v[92:95], a[56:59], v[96:99]
    v_mfma_f32_16x16x32_bf16 v[104:107], v[92:95], v[120:123], v[104:107]
    s_waitcnt lgkmcnt(0)
    v_mfma_f32_32x32x16_bf16 v[128:143], v[112:115], a[64:67], v[128:143]
    s_add_u32 m0, s89, 16384
    s_lshl_b32 s96, s97, 8
    buffer_load_dwordx4 v6, s[36:39], s71 offen offset:0 lds
    ds_read_b128 a[72:75], v77 offset:0
    ds_read_b64_tr_b16 v[120:121], v32 offset:18432
    ds_read_b64_tr_b16 v[122:123], v32 offset:18944
    v_mfma_f32_32x32x16_bf16 v[144:159], v[112:115], a[68:71], v[144:159]
    ds_read_b128 a[76:79], v81 offset:0
    ds_read_b64_tr_b16 v[124:125], v33 offset:18432
    ds_read_b64_tr_b16 v[126:127], v33 offset:18944
    v_mfma_f32_32x32x16_bf16 v[160:175], v[116:119], a[64:67], v[160:175]
    buffer_load_dwordx4 v7, s[36:39], s71 offen offset:1024 lds
    v_mfma_f32_32x32x16_bf16 v[176:191], v[116:119], a[68:71], v[176:191]
    buffer_load_dwordx4 v8, s[36:39], s71 offen offset:2048 lds
    v_mfma_f32_4x4x4_16b_bf16 v[100:103], a[64:65], a[64:65], v[100:103]
    v_mfma_f32_4x4x4_16b_bf16 v[88:91], a[66:67], a[66:67], v[88:91]
    v_mfma_f32_16x16x32_bf16 v[96:99], v[92:95], a[64:67], v[96:99]
    v_mfma_f32_16x16x32_bf16 v[104:107], v[92:95], v[112:115], v[104:107]
    s_waitcnt lgkmcnt(0)
    v_mfma_f32_32x32x16_bf16 v[128:143], v[120:123], a[72:75], v[128:143]
    buffer_load_dwordx4 v9, s[36:39], s71 offen offset:3072 lds
    ds_read_b128 a[80:83], v78 offset:0
    ds_read_b64_tr_b16 v[112:113], v32 offset:20480
    ds_read_b64_tr_b16 v[114:115], v32 offset:20992
    v_mfma_f32_32x32x16_bf16 v[144:159], v[120:123], a[76:79], v[144:159]
    ds_read_b128 a[84:87], v82 offset:0
    ds_read_b64_tr_b16 v[116:117], v33 offset:20480
    ds_read_b64_tr_b16 v[118:119], v33 offset:20992
    v_mfma_f32_32x32x16_bf16 v[160:175], v[124:127], a[72:75], v[160:175]
    s_cmp_eq_u32 s88, 0
    s_cselect_b32 s13, 0, 2130706432
    v_lshl_add_u32 v254, s2, 6, v1
    v_lshlrev_b32 v254, 7, v254
    buffer_load_dword v255, v254, s[40:43], s13 offen
    v_mfma_f32_32x32x16_bf16 v[176:191], v[124:127], a[76:79], v[176:191]
    s_add_u32 m0, s89, 32768
    s_add_u32 s100, s95, s96
    buffer_load_dwordx4 v2, s[32:35], s65 offen offset:0 lds
    v_mfma_f32_4x4x4_16b_bf16 v[100:103], a[72:73], a[72:73], v[100:103]
    v_mfma_f32_4x4x4_16b_bf16 v[88:91], a[74:75], a[74:75], v[88:91]
    v_mfma_f32_16x16x32_bf16 v[96:99], v[92:95], a[72:75], v[96:99]
    v_mfma_f32_16x16x32_bf16 v[104:107], v[92:95], v[120:123], v[104:107]
    s_waitcnt lgkmcnt(0)
    v_mfma_f32_32x32x16_bf16 v[128:143], v[112:115], a[80:83], v[128:143]
    buffer_load_dwordx4 v3, s[32:35], s65 offen offset:1024 lds
    ds_read_b128 a[88:91], v79 offset:0
    ds_read_b64_tr_b16 v[120:121], v32 offset:22528
    ds_read_b64_tr_b16 v[122:123], v32 offset:23040
    v_mfma_f32_32x32x16_bf16 v[144:159], v[112:115], a[84:87], v[144:159]
    ds_read_b128 a[92:95], v83 offset:0
    ds_read_b64_tr_b16 v[124:125], v33 offset:22528
    ds_read_b64_tr_b16 v[126:127], v33 offset:23040
    v_mfma_f32_32x32x16_bf16 v[160:175], v[116:119], a[80:83], v[160:175]
    v_mfma_f32_32x32x16_bf16 v[176:191], v[116:119], a[84:87], v[176:191]
    buffer_load_dwordx4 v4, s[32:35], s65 offen offset:2048 lds
    v_mfma_f32_4x4x4_16b_bf16 v[100:103], a[80:81], a[80:81], v[100:103]
    v_mfma_f32_4x4x4_16b_bf16 v[88:91], a[82:83], a[82:83], v[88:91]
    v_mfma_f32_16x16x32_bf16 v[96:99], v[92:95], a[80:83], v[96:99]
    v_mfma_f32_16x16x32_bf16 v[104:107], v[92:95], v[112:115], v[104:107]
    s_waitcnt lgkmcnt(0)
    v_mfma_f32_32x32x16_bf16 v[128:143], v[120:123], a[88:91], v[128:143]
    v_add_u32 v14, s100, v14
    v_add_u32 v21, 1024, v14
    v_add_u32 v22, 2048, v14
    v_add_u32 v23, 3072, v14
    v_bfe_u32 v56, v1, 3, 1
    v_mul_u32_u24 v56, 4160, v56
    v_lshl_add_u32 v56, v45, 2, v56
    v_add_u32 v56, s95, v56
    s_cmp_eq_u32 s97, 0
    s_cselect_b32 s100, 16, 0
    v_mov_b32 v57, 157696
    v_cmp_gt_u32 vcc, s100, v1
    s_nop 1
    v_cndmask_b32 v210, v57, v56, vcc
    s_lshl3_add_u32 s95, s96, s95
    s_add_u32 s95, s95, 32
    v_add_u32 v209, s95, v40
    s_mul_i32 s95, s98, 4608
    s_add_u32 s95, s95, 147712
    v_lshl_add_u32 v208, v1, 3, s95
    s_lshl3_add_u32 s100, s96, s95
    v_add_u32 v20, s100, v40
    s_add_u32 s95, s95, s96
    s_add_u32 s95, s95, 480
    v_lshlrev_b32 v56, 4, v46
    v_lshlrev_b32 v57, 5, v47
    v_sub_u32 v56, v56, v57
    v_add_u32 v15, s95, v56
    s_lshl_b32 s95, s98, 4
    s_lshr_b32 s99, s99, s95
    s_and_b32 s99, s99, 0xffff
    s_cmp_eq_u32 s97, 0
    s_cselect_b32 s99, s99, 0
    v_lshl_add_u32 v56, v46, 3, v47
    v_sub_u32 v56, 15, v56
    v_and_b32 v57, 1, v56
    v_lshlrev_b32 v57, 4, v57
    v_lshlrev_b32 v57, v57, s99
    v_ashrrev_i32 v56, 1, v56
    v_cmp_eq_u32 vcc, 0, v56
    s_nop 1
    v_cndmask_b32 v16, 0, v57, vcc
    v_cmp_eq_u32 vcc, 1, v56
    s_nop 1
    v_cndmask_b32 v17, 0, v57, vcc
    v_cmp_eq_u32 vcc, 2, v56
    s_nop 1
    v_cndmask_b32 v18, 0, v57, vcc
    v_cmp_eq_u32 vcc, 3, v56
    s_nop 1
    v_cndmask_b32 v19, 0, v57, vcc
    v_lshlrev_b32 v47, 3, v1
    s_lshl_b32 s95, s88, 9
    v_add_u32 v47, s95, v47
    v_add_u32 v26, 159744, v47
    v_add_u32 v25, 157696, v47
    v_mov_b32 v54, 0
    v_mov_b32 v55, 0
    v_mov_b32 v58, 0
    v_mov_b32 v59, 0
    v_mov_b32 v62, 0
    v_mov_b32 v63, 0
    v_mov_b32 v66, 0
    v_mov_b32 v67, 0
    s_waitcnt vmcnt(12)
    ds_write_b128 v209, v[192:195] offset:0
    v_alignbit_b32 v204, v193, v192, 16
    v_alignbit_b32 v205, v194, v193, 16
    v_alignbit_b32 v206, v195, v194, 16
    v_alignbit_b32 v207, v200, v195, 16
    ds_write_b128 v209, v[204:207] offset:4160
    ds_write_b128 v209, v[196:199] offset:1024
    v_alignbit_b32 v204, v197, v196, 16
    v_alignbit_b32 v205, v198, v197, 16
    v_alignbit_b32 v206, v199, v198, 16
    v_alignbit_b32 v207, v201, v199, 16
    ds_write_b128 v209, v[204:207] offset:5184
    v_readfirstlane_b32 s95, v192
    v_mov_b32 v204, 0
    v_mov_b32 v205, 0
    s_lshl_b32 s95, s95, 16
    ds_write_b64 v208, v[204:205] offset:4096
    v_mov_b32 v206, 0
    v_writelane_b32 v206, s95, 15
    ds_write_b32 v210, v206
    s_barrier
    buffer_load_dwordx4 v5, s[32:35], s65 offen offset:3072 lds
    ds_read_b128 a[96:99], v76 offset:32768
    ds_read_b64_tr_b16 v[112:113], v32 offset:49152
    ds_read_b64_tr_b16 v[114:115], v32 offset:49664
    v_mfma_f32_32x32x16_bf16 v[144:159], v[120:123], a[92:95], v[144:159]
    ds_read_b128 a[100:103], v80 offset:32768
    ds_read_b64_tr_b16 v[116:117], v33 offset:49152
    ds_read_b64_tr_b16 v[118:119], v33 offset:49664
    v_mfma_f32_32x32x16_bf16 v[160:175], v[124:127], a[88:91], v[160:175]
    s_add_u32 m0, s89, 49152
    s_nop 0
    buffer_load_dwordx4 v6, s[36:39], s72 offen offset:0 lds
    v_mfma_f32_32x32x16_bf16 v[176:191], v[124:127], a[92:95], v[176:191]
    buffer_load_dwordx4 v7, s[36:39], s72 offen offset:1024 lds
    v_mfma_f32_4x4x4_16b_bf16 v[100:103], a[88:89], a[88:89], v[100:103]
    v_mfma_f32_4x4x4_16b_bf16 v[88:91], a[90:91], a[90:91], v[88:91]
    v_mfma_f32_16x16x32_bf16 v[96:99], v[92:95], a[88:91], v[96:99]
    v_mfma_f32_16x16x32_bf16 v[104:107], v[92:95], v[120:123], v[104:107]
    s_waitcnt lgkmcnt(0)
    v_mfma_f32_32x32x16_bf16 v[128:143], v[112:115], a[96:99], v[128:143]
    buffer_load_dwordx4 v8, s[36:39], s72 offen offset:2048 lds
    ds_read_b128 a[104:107], v77 offset:32768
    ds_read_b64_tr_b16 v[120:121], v32 offset:51200
    ds_read_b64_tr_b16 v[122:123], v32 offset:51712
    v_mfma_f32_32x32x16_bf16 v[144:159], v[112:115], a[100:103], v[144:159]
    ds_read_b128 a[108:111], v81 offset:32768
    ds_read_b64_tr_b16 v[124:125], v33 offset:51200
    ds_read_b64_tr_b16 v[126:127], v33 offset:51712
    v_mfma_f32_32x32x16_bf16 v[160:175], v[116:119], a[96:99], v[160:175]
    buffer_load_dwordx4 v9, s[36:39], s72 offen offset:3072 lds
    v_mfma_f32_32x32x16_bf16 v[176:191], v[116:119], a[100:103], v[176:191]
    s_add_u32 m0, s89, 65536
    s_nop 0
    buffer_load_dwordx4 v2, s[32:35], s66 offen offset:0 lds
    v_mfma_f32_4x4x4_16b_bf16 v[100:103], a[96:97], a[96:97], v[100:103]
    v_mfma_f32_4x4x4_16b_bf16 v[88:91], a[98:99], a[98:99], v[88:91]
    v_mfma_f32_16x16x32_bf16 v[96:99], v[92:95], a[96:99], v[96:99]
    v_mfma_f32_16x16x32_bf16 v[104:107], v[92:95], v[112:115], v[104:107]
    s_waitcnt lgkmcnt(0)
    v_mfma_f32_32x32x16_bf16 v[128:143], v[120:123], a[104:107], v[128:143]
    buffer_load_dwordx4 v3, s[32:35], s66 offen offset:1024 lds
    ds_read_b128 a[112:115], v78 offset:32768
    ds_read_b64_tr_b16 v[112:113], v32 offset:53248
    ds_read_b64_tr_b16 v[114:115], v32 offset:53760
    v_mfma_f32_32x32x16_bf16 v[144:159], v[120:123], a[108:111], v[144:159]
    ds_read_b128 a[116:119], v82 offset:32768
    ds_read_b64_tr_b16 v[116:117], v33 offset:53248
    ds_read_b64_tr_b16 v[118:119], v33 offset:53760
    v_mfma_f32_32x32x16_bf16 v[160:175], v[124:127], a[104:107], v[160:175]
    v_mfma_f32_32x32x16_bf16 v[176:191], v[124:127], a[108:111], v[176:191]
    buffer_load_dwordx4 v4, s[32:35], s66 offen offset:2048 lds
    v_mfma_f32_4x4x4_16b_bf16 v[100:103], a[104:105], a[104:105], v[100:103]
    v_mfma_f32_4x4x4_16b_bf16 v[88:91], a[106:107], a[106:107], v[88:91]
    v_mfma_f32_16x16x32_bf16 v[96:99], v[92:95], a[104:107], v[96:99]
    v_mfma_f32_16x16x32_bf16 v[104:107], v[92:95], v[120:123], v[104:107]
    s_waitcnt lgkmcnt(0)
    v_mfma_f32_32x32x16_bf16 v[128:143], v[112:115], a[112:115], v[128:143]
    buffer_load_dwordx4 v5, s[32:35], s66 offen offset:3072 lds
    ds_read_b128 a[120:123], v79 offset:32768
    ds_read_b64_tr_b16 v[120:121], v32 offset:55296
    ds_read_b64_tr_b16 v[122:123], v32 offset:55808
    v_mfma_f32_32x32x16_bf16 v[144:159], v[112:115], a[116:119], v[144:159]
    ds_read_b128 a[124:127], v83 offset:32768
    ds_read_b64_tr_b16 v[124:125], v33 offset:55296
    ds_read_b64_tr_b16 v[126:127], v33 offset:55808
    v_mfma_f32_32x32x16_bf16 v[160:175], v[116:119], a[112:115], v[160:175]
    v_mfma_f32_32x32x16_bf16 v[176:191], v[116:119], a[116:119], v[176:191]
    s_add_u32 m0, s89, 81920
    s_nop 0
    buffer_load_dwordx4 v6, s[36:39], s73 offen offset:0 lds
    v_mfma_f32_4x4x4_16b_bf16 v[100:103], a[112:113], a[112:113], v[100:103]
    v_mfma_f32_4x4x4_16b_bf16 v[88:91], a[114:115], a[114:115], v[88:91]
    v_mfma_f32_16x16x32_bf16 v[96:99], v[92:95], a[112:115], v[96:99]
    v_mfma_f32_16x16x32_bf16 v[104:107], v[92:95], v[112:115], v[104:107]
    s_waitcnt lgkmcnt(0)
    v_mfma_f32_32x32x16_bf16 v[128:143], v[120:123], a[120:123], v[128:143]
    s_waitcnt vmcnt(14)
    s_barrier
    buffer_load_dwordx4 v7, s[36:39], s73 offen offset:1024 lds
    ds_read_b128 a[128:131], v68 offset:0
    ds_read_b64_tr_b16 v[112:113], v30 offset:16384
    ds_read_b64_tr_b16 v[114:115], v30 offset:16896
    v_mfma_f32_32x32x16_bf16 v[144:159], v[120:123], a[124:127], v[144:159]
    ds_read_b128 a[132:135], v72 offset:0
    ds_read_b64_tr_b16 v[116:117], v31 offset:16384
    ds_read_b64_tr_b16 v[118:119], v31 offset:16896
    v_mfma_f32_32x32x16_bf16 v[160:175], v[124:127], a[120:123], v[160:175]
    buffer_load_dwordx4 v8, s[36:39], s73 offen offset:2048 lds
    v_mfma_f32_32x32x16_bf16 v[176:191], v[124:127], a[124:127], v[176:191]
    buffer_load_dwordx4 v9, s[36:39], s73 offen offset:3072 lds
    v_mfma_f32_4x4x4_16b_bf16 v[100:103], a[120:121], a[120:121], v[100:103]
    v_mfma_f32_4x4x4_16b_bf16 v[88:91], a[122:123], a[122:123], v[88:91]
    v_mfma_f32_16x16x32_bf16 v[96:99], v[92:95], a[120:123], v[96:99]
    v_mfma_f32_16x16x32_bf16 v[104:107], v[92:95], v[120:123], v[104:107]
    s_waitcnt lgkmcnt(0)
    v_mfma_f32_32x32x16_bf16 v[128:143], v[112:115], a[128:131], v[128:143]
    v_add_u32 v6, 128, v6
    v_add_u32 v7, 128, v7
    v_add_u32 v8, 128, v8
    v_add_u32 v9, 128, v9
    s_add_u32 m0, s89, 98304
    s_nop 0
    buffer_load_dwordx4 v6, s[36:39], s67 offen offset:0 lds
    ds_read_b128 a[136:139], v69 offset:0
    ds_read_b64_tr_b16 v[120:121], v30 offset:18432
    ds_read_b64_tr_b16 v[122:123], v30 offset:18944
    v_mfma_f32_32x32x16_bf16 v[144:159], v[112:115], a[132:135], v[144:159]
    ds_read_b128 a[140:143], v73 offset:0
    ds_read_b64_tr_b16 v[124:125], v31 offset:18432
    ds_read_b64_tr_b16 v[126:127], v31 offset:18944
    v_mfma_f32_32x32x16_bf16 v[160:175], v[116:119], a[128:131], v[160:175]
    v_mfma_f32_32x32x16_bf16 v[176:191], v[116:119], a[132:135], v[176:191]
    buffer_load_dwordx4 v7, s[36:39], s67 offen offset:1024 lds
    v_mfma_f32_4x4x4_16b_bf16 v[100:103], a[128:129], a[128:129], v[100:103]
    v_mfma_f32_4x4x4_16b_bf16 v[88:91], a[130:131], a[130:131], v[88:91]
    v_mfma_f32_16x16x32_bf16 v[96:99], v[92:95], a[128:131], v[96:99]
    v_mfma_f32_16x16x32_bf16 v[104:107], v[92:95], v[112:115], v[104:107]
    s_waitcnt lgkmcnt(0)
    v_mfma_f32_32x32x16_bf16 v[128:143], v[120:123], a[136:139], v[128:143]
    buffer_load_dwordx4 v8, s[36:39], s67 offen offset:2048 lds
    ds_read_b128 a[144:147], v70 offset:0
    ds_read_b64_tr_b16 v[112:113], v30 offset:20480
    ds_read_b64_tr_b16 v[114:115], v30 offset:20992
    v_mfma_f32_32x32x16_bf16 v[144:159], v[120:123], a[140:143], v[144:159]
    ds_read_b128 a[148:151], v74 offset:0
    ds_read_b64_tr_b16 v[116:117], v31 offset:20480
    ds_read_b64_tr_b16 v[118:119], v31 offset:20992
    v_mfma_f32_32x32x16_bf16 v[160:175], v[124:127], a[136:139], v[160:175]
    v_mfma_f32_32x32x16_bf16 v[176:191], v[124:127], a[140:143], v[176:191]
    buffer_load_dwordx4 v9, s[36:39], s67 offen offset:3072 lds
    v_mfma_f32_4x4x4_16b_bf16 v[100:103], a[136:137], a[136:137], v[100:103]
    v_mfma_f32_4x4x4_16b_bf16 v[88:91], a[138:139], a[138:139], v[88:91]
    v_mfma_f32_16x16x32_bf16 v[96:99], v[92:95], a[136:139], v[96:99]
    v_mfma_f32_16x16x32_bf16 v[104:107], v[92:95], v[120:123], v[104:107]
    s_waitcnt lgkmcnt(0)
    v_mfma_f32_32x32x16_bf16 v[128:143], v[112:115], a[144:147], v[128:143]
    s_add_u32 m0, s89, 114688
    s_nop 0
    buffer_load_dwordx4 v6, s[36:39], s68 offen offset:0 lds
    ds_read_b128 a[152:155], v71 offset:0
    ds_read_b64_tr_b16 v[120:121], v30 offset:22528
    ds_read_b64_tr_b16 v[122:123], v30 offset:23040
    v_mfma_f32_32x32x16_bf16 v[144:159], v[112:115], a[148:151], v[144:159]
    ds_read_b128 a[156:159], v75 offset:0
    ds_read_b64_tr_b16 v[124:125], v31 offset:22528
    ds_read_b64_tr_b16 v[126:127], v31 offset:23040
    v_mfma_f32_32x32x16_bf16 v[160:175], v[116:119], a[144:147], v[160:175]
    v_mfma_f32_32x32x16_bf16 v[176:191], v[116:119], a[148:151], v[176:191]
    buffer_load_dwordx4 v7, s[36:39], s68 offen offset:1024 lds
    v_mfma_f32_4x4x4_16b_bf16 v[100:103], a[144:145], a[144:145], v[100:103]
    v_mfma_f32_4x4x4_16b_bf16 v[88:91], a[146:147], a[146:147], v[88:91]
    v_mfma_f32_16x16x32_bf16 v[96:99], v[92:95], a[144:147], v[96:99]
    v_mfma_f32_16x16x32_bf16 v[104:107], v[92:95], v[112:115], v[104:107]
    s_waitcnt lgkmcnt(0)
    v_mfma_f32_32x32x16_bf16 v[128:143], v[120:123], a[152:155], v[128:143]
    s_waitcnt vmcnt(14)
    s_barrier
    buffer_load_dwordx4 v8, s[36:39], s68 offen offset:2048 lds
    ds_read_b128 a[160:163], v68 offset:32768
    ds_read_b64_tr_b16 v[112:113], v30 offset:49152
    ds_read_b64_tr_b16 v[114:115], v30 offset:49664
    v_mfma_f32_32x32x16_bf16 v[144:159], v[120:123], a[156:159], v[144:159]
    ds_read_b128 a[164:167], v72 offset:32768
    ds_read_b64_tr_b16 v[116:117], v31 offset:49152
    ds_read_b64_tr_b16 v[118:119], v31 offset:49664
    v_mfma_f32_32x32x16_bf16 v[160:175], v[124:127], a[152:155], v[160:175]
    v_mfma_f32_32x32x16_bf16 v[176:191], v[124:127], a[156:159], v[176:191]
    buffer_load_dwordx4 v9, s[36:39], s68 offen offset:3072 lds
    v_mfma_f32_4x4x4_16b_bf16 v[100:103], a[152:153], a[152:153], v[100:103]
    v_mfma_f32_4x4x4_16b_bf16 v[88:91], a[154:155], a[154:155], v[88:91]
    v_mfma_f32_16x16x32_bf16 v[96:99], v[92:95], a[152:155], v[96:99]
    v_mfma_f32_16x16x32_bf16 v[104:107], v[92:95], v[120:123], v[104:107]
    s_waitcnt lgkmcnt(0)
    v_mfma_f32_32x32x16_bf16 v[128:143], v[112:115], a[160:163], v[128:143]
    s_mov_b32 m0, s89
    s_nop 0
    buffer_load_dwordx4 v6, s[36:39], s69 offen offset:0 lds
    ds_read_b128 a[168:171], v69 offset:32768
    ds_read_b64_tr_b16 v[120:121], v30 offset:51200
    ds_read_b64_tr_b16 v[122:123], v30 offset:51712
    v_mfma_f32_32x32x16_bf16 v[144:159], v[112:115], a[164:167], v[144:159]
    ds_read_b128 a[172:175], v73 offset:32768
    ds_read_b64_tr_b16 v[124:125], v31 offset:51200
    ds_read_b64_tr_b16 v[126:127], v31 offset:51712
    v_mfma_f32_32x32x16_bf16 v[160:175], v[116:119], a[160:163], v[160:175]
    v_mfma_f32_32x32x16_bf16 v[176:191], v[116:119], a[164:167], v[176:191]
    buffer_load_dwordx4 v7, s[36:39], s69 offen offset:1024 lds
    v_mfma_f32_4x4x4_16b_bf16 v[100:103], a[160:161], a[160:161], v[100:103]
    v_mfma_f32_4x4x4_16b_bf16 v[88:91], a[162:163], a[162:163], v[88:91]
    v_mfma_f32_16x16x32_bf16 v[96:99], v[92:95], a[160:163], v[96:99]
    v_mfma_f32_16x16x32_bf16 v[104:107], v[92:95], v[112:115], v[104:107]
    s_waitcnt lgkmcnt(0)
    v_mfma_f32_32x32x16_bf16 v[128:143], v[120:123], a[168:171], v[128:143]
    buffer_load_dwordx4 v8, s[36:39], s69 offen offset:2048 lds
    ds_read_b128 a[176:179], v70 offset:32768
    ds_read_b64_tr_b16 v[112:113], v30 offset:53248
    ds_read_b64_tr_b16 v[114:115], v30 offset:53760
    v_mfma_f32_32x32x16_bf16 v[144:159], v[120:123], a[172:175], v[144:159]
    ds_read_b128 a[180:183], v74 offset:32768
    ds_read_b64_tr_b16 v[116:117], v31 offset:53248
    ds_read_b64_tr_b16 v[118:119], v31 offset:53760
    v_mfma_f32_32x32x16_bf16 v[160:175], v[124:127], a[168:171], v[160:175]
    v_mfma_f32_32x32x16_bf16 v[176:191], v[124:127], a[172:175], v[176:191]
    buffer_load_dwordx4 v9, s[36:39], s69 offen offset:3072 lds
    v_mfma_f32_4x4x4_16b_bf16 v[100:103], a[168:169], a[168:169], v[100:103]
    v_mfma_f32_4x4x4_16b_bf16 v[88:91], a[170:171], a[170:171], v[88:91]
    v_mfma_f32_16x16x32_bf16 v[96:99], v[92:95], a[168:171], v[96:99]
    v_mfma_f32_16x16x32_bf16 v[104:107], v[92:95], v[120:123], v[104:107]
    s_waitcnt lgkmcnt(0)
    v_mfma_f32_32x32x16_bf16 v[128:143], v[112:115], a[176:179], v[128:143]
    ds_read_b128 a[184:187], v71 offset:32768
    ds_read_b64_tr_b16 v[120:121], v30 offset:55296
    ds_read_b64_tr_b16 v[122:123], v30 offset:55808
    v_mfma_f32_32x32x16_bf16 v[144:159], v[112:115], a[180:183], v[144:159]
    ds_read_b128 a[188:191], v75 offset:32768
    ds_read_b64_tr_b16 v[124:125], v31 offset:55296
    ds_read_b64_tr_b16 v[126:127], v31 offset:55808
    v_mfma_f32_32x32x16_bf16 v[160:175], v[116:119], a[176:179], v[160:175]
    v_mfma_f32_32x32x16_bf16 v[176:191], v[116:119], a[180:183], v[176:191]
    v_mfma_f32_4x4x4_16b_bf16 v[100:103], a[176:177], a[176:177], v[100:103]
    v_mfma_f32_4x4x4_16b_bf16 v[88:91], a[178:179], a[178:179], v[88:91]
    v_mfma_f32_16x16x32_bf16 v[96:99], v[92:95], a[176:179], v[96:99]
    v_mfma_f32_16x16x32_bf16 v[104:107], v[92:95], v[112:115], v[104:107]
    s_waitcnt lgkmcnt(0)
    v_mfma_f32_32x32x16_bf16 v[128:143], v[120:123], a[184:187], v[128:143]
    s_waitcnt vmcnt(12)
    s_barrier
    s_add_u32 m0, s89, 16384
    s_nop 0
    buffer_load_dwordx4 v10, s[40:43], s74 offen offset:0 lds
    ds_read_b128 a[192:195], v76 offset:0
    ds_read_b64_tr_b16 v[112:113], v32 offset:16384
    ds_read_b64_tr_b16 v[114:115], v32 offset:16896
    v_mfma_f32_32x32x16_bf16 v[144:159], v[120:123], a[188:191], v[144:159]
    ds_read_b128 a[196:199], v80 offset:0
    ds_read_b64_tr_b16 v[116:117], v33 offset:16384
    ds_read_b64_tr_b16 v[118:119], v33 offset:16896
    v_mfma_f32_32x32x16_bf16 v[160:175], v[124:127], a[184:187], v[160:175]
    v_mfma_f32_32x32x16_bf16 v[176:191], v[124:127], a[188:191], v[176:191]
    buffer_load_dwordx4 v11, s[40:43], s74 offen offset:1024 lds
    v_mfma_f32_4x4x4_16b_bf16 v[100:103], a[184:185], a[184:185], v[100:103]
    v_mfma_f32_4x4x4_16b_bf16 v[88:91], a[186:187], a[186:187], v[88:91]
    v_mfma_f32_16x16x32_bf16 v[96:99], v[92:95], a[184:187], v[96:99]
    v_mfma_f32_16x16x32_bf16 v[104:107], v[92:95], v[120:123], v[104:107]
    s_waitcnt lgkmcnt(0)
    v_mfma_f32_32x32x16_bf16 v[128:143], v[112:115], a[192:195], v[128:143]
    buffer_load_dwordx4 v12, s[40:43], s74 offen offset:2048 lds
    ds_read_b128 a[200:203], v77 offset:0
    ds_read_b64_tr_b16 v[120:121], v32 offset:18432
    ds_read_b64_tr_b16 v[122:123], v32 offset:18944
    v_mfma_f32_32x32x16_bf16 v[144:159], v[112:115], a[196:199], v[144:159]
    ds_read_b128 a[204:207], v81 offset:0
    ds_read_b64_tr_b16 v[124:125], v33 offset:18432
    ds_read_b64_tr_b16 v[126:127], v33 offset:18944
    v_mfma_f32_32x32x16_bf16 v[160:175], v[116:119], a[192:195], v[160:175]
    v_mfma_f32_32x32x16_bf16 v[176:191], v[116:119], a[196:199], v[176:191]
    buffer_load_dwordx4 v13, s[40:43], s74 offen offset:3072 lds
    v_mfma_f32_4x4x4_16b_bf16 v[100:103], a[192:193], a[192:193], v[100:103]
    v_mfma_f32_4x4x4_16b_bf16 v[88:91], a[194:195], a[194:195], v[88:91]
    v_mfma_f32_16x16x32_bf16 v[96:99], v[92:95], a[192:195], v[96:99]
    v_mfma_f32_16x16x32_bf16 v[104:107], v[92:95], v[112:115], v[104:107]
    s_waitcnt lgkmcnt(0)
    v_mfma_f32_32x32x16_bf16 v[128:143], v[120:123], a[200:203], v[128:143]
    ds_read_b128 a[208:211], v78 offset:0
    ds_read_b64_tr_b16 v[112:113], v32 offset:20480
    ds_read_b64_tr_b16 v[114:115], v32 offset:20992
    v_mfma_f32_32x32x16_bf16 v[144:159], v[120:123], a[204:207], v[144:159]
    ds_read_b128 a[212:215], v82 offset:0
    ds_read_b64_tr_b16 v[116:117], v33 offset:20480
    ds_read_b64_tr_b16 v[118:119], v33 offset:20992
    v_mfma_f32_32x32x16_bf16 v[160:175], v[124:127], a[200:203], v[160:175]
    v_mfma_f32_32x32x16_bf16 v[176:191], v[124:127], a[204:207], v[176:191]
    v_mfma_f32_4x4x4_16b_bf16 v[100:103], a[200:201], a[200:201], v[100:103]
    v_mfma_f32_4x4x4_16b_bf16 v[88:91], a[202:203], a[202:203], v[88:91]
    v_mfma_f32_16x16x32_bf16 v[96:99], v[92:95], a[200:203], v[96:99]
    v_mfma_f32_16x16x32_bf16 v[104:107], v[92:95], v[120:123], v[104:107]
    s_waitcnt lgkmcnt(0)
    v_mfma_f32_32x32x16_bf16 v[128:143], v[112:115], a[208:211], v[128:143]
    ds_read_b128 a[216:219], v79 offset:0
    ds_read_b64_tr_b16 v[120:121], v32 offset:22528
    ds_read_b64_tr_b16 v[122:123], v32 offset:23040
    v_mfma_f32_32x32x16_bf16 v[144:159], v[112:115], a[212:215], v[144:159]
    ds_read_b128 a[220:223], v83 offset:0
    ds_read_b64_tr_b16 v[124:125], v33 offset:22528
    ds_read_b64_tr_b16 v[126:127], v33 offset:23040
    v_mfma_f32_32x32x16_bf16 v[160:175], v[116:119], a[208:211], v[160:175]
    v_mfma_f32_32x32x16_bf16 v[176:191], v[116:119], a[212:215], v[176:191]
    v_mfma_f32_4x4x4_16b_bf16 v[100:103], a[208:209], a[208:209], v[100:103]
    v_mfma_f32_4x4x4_16b_bf16 v[88:91], a[210:211], a[210:211], v[88:91]
    v_mfma_f32_16x16x32_bf16 v[96:99], v[92:95], a[208:211], v[96:99]
    v_mfma_f32_16x16x32_bf16 v[104:107], v[92:95], v[112:115], v[104:107]
    s_waitcnt lgkmcnt(0)
    v_mfma_f32_32x32x16_bf16 v[128:143], v[120:123], a[216:219], v[128:143]
    s_waitcnt vmcnt(12)
    s_barrier
    s_add_u32 m0, s89, 32768
    s_nop 0
    buffer_load_dwordx4 v10, s[40:43], s75 offen offset:0 lds
    ds_read_b64_tr_b16 v[112:113], v32 offset:32768
    ds_read_b64_tr_b16 v[114:115], v32 offset:33280
    v_mfma_f32_32x32x16_bf16 v[144:159], v[120:123], a[220:223], v[144:159]
    ds_read_b64_tr_b16 v[116:117], v33 offset:32768
    ds_read_b64_tr_b16 v[118:119], v33 offset:33280
    v_mfma_f32_32x32x16_bf16 v[160:175], v[124:127], a[216:219], v[160:175]
    buffer_load_dwordx4 v11, s[40:43], s75 offen offset:1024 lds
    v_mfma_f32_32x32x16_bf16 v[176:191], v[124:127], a[220:223], v[176:191]
    buffer_load_dwordx4 v12, s[40:43], s75 offen offset:2048 lds
    v_mfma_f32_4x4x4_16b_bf16 v[100:103], a[216:217], a[216:217], v[100:103]
    v_mfma_f32_4x4x4_16b_bf16 v[88:91], a[218:219], a[218:219], v[88:91]
    v_mfma_f32_16x16x32_bf16 v[96:99], v[92:95], a[216:219], v[96:99]
    v_mfma_f32_16x16x32_bf16 v[104:107], v[92:95], v[120:123], v[104:107]
    s_waitcnt lgkmcnt(0)
    v_mfma_f32_32x32x16_bf16 v[192:207], v[112:115], a[0:3], 0
    ds_read_b64_tr_b16 v[120:121], v32 offset:34816
    ds_read_b64_tr_b16 v[122:123], v32 offset:35328
    ds_read_b64_tr_b16 v[124:125], v33 offset:34816
    ds_read_b64_tr_b16 v[126:127], v33 offset:35328
    v_mfma_f32_32x32x16_bf16 v[208:223], v[112:115], a[4:7], 0
    buffer_load_dwordx4 v13, s[40:43], s75 offen offset:3072 lds
    v_add_f32 v100, v100, v88
    v_add_f32 v101, v101, v89
    v_add_f32 v102, v102, v90
    v_add_f32 v103, v103, v91
    v_cndmask_b32 v68, v100, v101, s[16:17]
    v_mfma_f32_32x32x16_bf16 v[224:239], v[116:119], a[0:3], 0
    s_add_u32 m0, s89, 49152
    v_cndmask_b32 v69, v102, v103, s[16:17]
    buffer_load_dwordx4 v10, s[40:43], s76 offen offset:0 lds
    v_cndmask_b32 v68, v68, v69, s[30:31]
    v_mul_f32 v70, 0xbb124925, v96
    v_mov_b32 v69, v68
    v_mfma_f32_32x32x16_bf16 v[240:255], v[116:119], a[4:7], 0
    buffer_load_dwordx4 v11, s[40:43], s76 offen offset:1024 lds
    v_cvt_pk_bf16_f32 v60, v70, v70
    v_mul_f32 v70, v70, v70
    v_permlane32_swap_b32 v68, v69
    v_add_f32 v68, v68, v69
    v_mov_b32 v61, v60
    v_mfma_f32_16x16x32_bf16 v[108:111], v[92:95], v[112:115], 0
    v_mov_b32 v84, v60
    v_mul_f32 v68, 0x3b124925, v68
    s_waitcnt lgkmcnt(0)
    v_mfma_f32_32x32x16_bf16 v[192:207], v[120:123], a[8:11], v[192:207]
    ds_read_b64_tr_b16 v[112:113], v32 offset:36864
    ds_read_b64_tr_b16 v[114:115], v32 offset:37376
    ds_read_b64_tr_b16 v[116:117], v33 offset:36864
    ds_read_b64_tr_b16 v[118:119], v33 offset:37376
    v_sub_f32 v68, v68, v70
    v_max_f32 v68, 0, v68
    v_mfma_f32_32x32x16_bf16 v[208:223], v[120:123], a[12:15], v[208:223]
    buffer_load_dwordx4 v12, s[40:43], s76 offen offset:2048 lds
    v_cvt_pk_bf16_f32 v68, v68, v68
    v_and_b32 v68, 0xffff0000, v68
    v_add_f32 v68, 0x3727c5ac, v68
    v_cvt_pk_bf16_f32 v68, v68, v68
    v_and_b32 v68, 0xffff0000, v68
    v_mfma_f32_32x32x16_bf16 v[224:239], v[124:127], a[8:11], v[224:239]
    buffer_load_dwordx4 v13, s[40:43], s76 offen offset:3072 lds
    v_sqrt_f32 v68, v68
    v_cndmask_b32 v104, v104, 0, s[0:1]
    v_cvt_pk_bf16_f32 v72, v104, v104
    v_and_b32 v73, 0xffff0000, v72
    v_mfma_f32_32x32x16_bf16 v[240:255], v[124:127], a[12:15], v[240:255]
    s_add_u32 m0, s89, 65536
    v_sub_f32 v104, v104, v73
    buffer_load_dwordx4 v10, s[40:43], s77 offen offset:0 lds
    v_cvt_pk_bf16_f32 v74, v104, v104
    v_and_b32 v73, 0xffff0000, v74
    v_sub_f32 v104, v104, v73
    v_mfma_f32_16x16x32_bf16 v[108:111], v[92:95], v[120:123], v[108:111]
    v_and_b32 v72, 0xffff, v72
    v_or_b32 v52, v72, v73
    s_waitcnt lgkmcnt(0)
    v_mfma_f32_32x32x16_bf16 v[192:207], v[112:115], a[16:19], v[192:207]
    ds_read_b64_tr_b16 v[120:121], v32 offset:38912
    ds_read_b64_tr_b16 v[122:123], v32 offset:39424
    ds_read_b64_tr_b16 v[124:125], v33 offset:38912
    ds_read_b64_tr_b16 v[126:127], v33 offset:39424
    v_cvt_pk_bf16_f32 v53, v104, 0
    v_cvt_pk_bf16_f32 v68, v68, v68
    v_mfma_f32_32x32x16_bf16 v[208:223], v[112:115], a[20:23], v[208:223]
    buffer_load_dwordx4 v11, s[40:43], s77 offen offset:1024 lds
    v_and_b32 v85, 0xffff0000, v68
    ds_write_b64 v26, v[84:85]
    ds_write_b64 v26, v[52:53] offset:2048
    v_rcp_f32 v51, v85
    v_mfma_f32_32x32x16_bf16 v[224:239], v[116:119], a[16:19], v[224:239]
    v_mul_f32 v48, v85, v85
    v_mul_f32 v44, 0xc0135761, v51
    v_mul_f32 v46, v51, v51
    v_mul_f32 v46, v46, v51
    v_mul_f32 v46, 0xbdd2d3e8, v46
    v_and_b32 v86, 0xffff0000, v84
    v_mfma_f32_32x32x16_bf16 v[240:255], v[116:119], a[20:23], v[240:255]
    buffer_load_dwordx4 v12, s[40:43], s77 offen offset:2048 lds
    v_mov_b32 v87, v51
    v_min_u32 v5, 27, v1
    s_lshl_b32 s95, s10, 7
    s_add_u32 s95, s95, 7405568
    s_cmp_eq_u32 s88, 0
    s_cselect_b32 s95, s95, 2130706432
    v_mfma_f32_16x16x32_bf16 v[108:111], v[92:95], v[112:115], v[108:111]
    v_lshl_add_u32 v5, v5, 2, s95
    v_xor_b32 v27, 1024, v26
    s_waitcnt lgkmcnt(0)
    v_xor_b32 v26, 512, v26
    v_mfma_f32_32x32x16_bf16 v[128:143], v[52:55], v[60:63], v[128:143]
    v_mfma_f32_32x32x16_bf16 v[192:207], v[120:123], a[24:27], v[192:207]
    s_waitcnt vmcnt(15)
    s_barrier
    ds_read_b64 v[84:85], v27
    ds_read_b64 v[56:57], v26 offset:2048
    ds_read_b64_tr_b16 v[112:113], v32 offset:49152
    ds_read_b64_tr_b16 v[114:115], v32 offset:49664
    ds_read_b64_tr_b16 v[116:117], v33 offset:49152
    ds_read_b64_tr_b16 v[118:119], v33 offset:49664
    v_mfma_f32_32x32x16_bf16 v[208:223], v[120:123], a[28:31], v[208:223]
    buffer_load_dwordx4 v13, s[40:43], s77 offen offset:3072 lds
    v_mfma_f32_32x32x16_bf16 v[224:239], v[124:127], a[24:27], v[224:239]
    s_add_u32 m0, s89, 81920
    v_mul_f32 v68, v128, v128
    buffer_load_dwordx4 v10, s[40:43], s78 offen offset:0 lds
    v_mul_f32 v69, v129, v129
    v_mul_f32 v70, v130, v130
    v_mul_f32 v71, v131, v131
    v_mfma_f32_32x32x16_bf16 v[240:255], v[124:127], a[28:31], v[240:255]
    buffer_load_dwordx4 v11, s[40:43], s78 offen offset:1024 lds
    v_fma_f32 v68, v68, v46, v44
    v_fma_f32 v69, v69, v46, v44
    v_fma_f32 v70, v70, v46, v44
    v_fma_f32 v71, v71, v46, v44
    v_mul_f32 v68, v128, v68
    v_mfma_f32_16x16x32_bf16 v[108:111], v[92:95], v[120:123], v[108:111]
    v_mul_f32 v69, v129, v69
    v_mul_f32 v70, v130, v70
    s_waitcnt lgkmcnt(0)
    v_mfma_f32_32x32x16_bf16 v[192:207], v[112:115], a[32:35], v[192:207]
    ds_read_b64_tr_b16 v[120:121], v32 offset:51200
    ds_read_b64_tr_b16 v[122:123], v32 offset:51712
    ds_read_b64_tr_b16 v[124:125], v33 offset:51200
    ds_read_b64_tr_b16 v[126:127], v33 offset:51712
    v_mul_f32 v71, v131, v71
    v_mfma_f32_32x32x16_bf16 v[208:223], v[112:115], a[36:39], v[208:223]
    buffer_load_dwordx4 v12, s[40:43], s78 offen offset:2048 lds
    v_exp_f32 v68, v68
    v_mul_f32 v72, v128, v132
    v_exp_f32 v69, v69
    v_mfma_f32_32x32x16_bf16 v[224:239], v[116:119], a[32:35], v[224:239]
    v_mul_f32 v73, v129, v133
    v_exp_f32 v70, v70
    v_mul_f32 v74, v130, v134
    v_exp_f32 v71, v71
    v_mfma_f32_32x32x16_bf16 v[240:255], v[116:119], a[36:39], v[240:255]
    buffer_load_dwordx4 v13, s[40:43], s78 offen offset:3072 lds
    v_mov_b32 v64, v84
    v_mov_b32 v65, v84
    v_rcp_f32 v51, v85
    v_mul_f32 v49, v85, v85
    v_mfma_f32_16x16x32_bf16 v[108:111], v[92:95], v[112:115], v[108:111]
    v_mul_f32 v75, v131, v135
    v_fma_f32 v68, v68, v48, v48
    s_waitcnt lgkmcnt(0)
    v_mul_f32 v45, 0xc0135761, v51
    v_mul_f32 v47, v51, v51
    v_mul_f32 v47, v47, v51
    v_mul_f32 v47, 0xbdd2d3e8, v47
    v_mfma_f32_32x32x16_bf16 v[144:159], v[52:55], v[64:67], v[144:159]
    s_waitcnt vmcnt(16)
    ds_read_b64_tr_b16 a[0:1], v34 offset:16384
    ds_read_b64_tr_b16 a[2:3], v34 offset:16896
    v_fma_f32 v69, v69, v48, v48
    v_fma_f32 v70, v70, v48, v48
    v_fma_f32 v71, v71, v48, v48
    v_mfma_f32_32x32x16_bf16 v[160:175], v[56:59], v[60:63], v[160:175]
    ds_read_b64_tr_b16 a[4:5], v35 offset:16384
    ds_read_b64_tr_b16 a[6:7], v35 offset:16896
    v_rcp_f32 v68, v68
    v_rcp_f32 v69, v69
    v_mfma_f32_32x32x16_bf16 v[176:191], v[56:59], v[64:67], v[176:191]
    ds_read_b64_tr_b16 a[8:9], v34 offset:18432
    ds_read_b64_tr_b16 a[10:11], v34 offset:18944
    v_rcp_f32 v70, v70
    v_rcp_f32 v71, v71
    v_mfma_f32_32x32x16_bf16 v[192:207], v[120:123], a[40:43], v[192:207]
    ds_read_b64_tr_b16 v[112:113], v32 offset:53248
    ds_read_b64_tr_b16 v[114:115], v32 offset:53760
    ds_read_b64_tr_b16 v[116:117], v33 offset:53248
    ds_read_b64_tr_b16 v[118:119], v33 offset:53760
    v_mul_f32 v72, v72, v68
    v_mul_f32 v73, v73, v69
    v_mfma_f32_32x32x16_bf16 v[208:223], v[120:123], a[44:47], v[208:223]
    s_add_u32 m0, s89, 98304
    v_mul_f32 v74, v74, v70
    buffer_load_dwordx4 v6, s[36:39], s70 offen offset:0 lds
    ds_read_b64_tr_b16 a[12:13], v35 offset:18432
    ds_read_b64_tr_b16 a[14:15], v35 offset:18944
    s_waitcnt vmcnt(13)
    v_mul_f32 v75, v75, v71
    v_mfma_f32_32x32x16_bf16 v[224:239], v[124:127], a[40:43], v[224:239]
    buffer_load_dwordx4 v7, s[36:39], s70 offen offset:1024 lds
    ds_read_b64_tr_b16 a[16:17], v34 offset:32768
    ds_read_b64_tr_b16 a[18:19], v34 offset:33280
    ds_read_b64_tr_b16 a[20:21], v35 offset:32768
    v_cvt_pk_bf16_f32 v128, v72, v73
    v_cvt_pk_bf16_f32 v129, v74, v75
    v_mfma_f32_32x32x16_bf16 v[240:255], v[124:127], a[44:47], v[240:255]
    buffer_load_dwordx4 v8, s[36:39], s70 offen offset:2048 lds
    v_mul_f32 v68, v136, v136
    v_mul_f32 v69, v137, v137
    v_mul_f32 v70, v138, v138
    v_mul_f32 v71, v139, v139
    v_fma_f32 v68, v68, v46, v44
    v_mfma_f32_16x16x32_bf16 v[108:111], v[92:95], v[120:123], v[108:111]
    v_fma_f32 v69, v69, v46, v44
    v_fma_f32 v70, v70, v46, v44
    s_waitcnt lgkmcnt(5)
    v_mfma_f32_32x32x16_bf16 v[192:207], v[112:115], a[48:51], v[192:207]
    ds_read_b64_tr_b16 v[120:121], v32 offset:55296
    ds_read_b64_tr_b16 v[122:123], v32 offset:55808
    ds_read_b64_tr_b16 v[124:125], v33 offset:55296
    ds_read_b64_tr_b16 v[126:127], v33 offset:55808
    v_fma_f32 v71, v71, v46, v44
    v_mul_f32 v68, v136, v68
    v_mfma_f32_32x32x16_bf16 v[208:223], v[112:115], a[52:55], v[208:223]
    buffer_load_dwordx4 v9, s[36:39], s70 offen offset:3072 lds
    ds_read_b64_tr_b16 a[22:23], v35 offset:33280
    ds_read_b64_tr_b16 a[24:25], v34 offset:34816
    v_mul_f32 v69, v137, v69
    v_mul_f32 v70, v138, v70
    v_mul_f32 v71, v139, v71
    v_mfma_f32_32x32x16_bf16 v[224:239], v[116:119], a[48:51], v[224:239]
    ds_read_b64_tr_b16 a[26:27], v34 offset:35328
    ds_read_b64_tr_b16 a[28:29], v35 offset:34816
    ds_read_b64_tr_b16 a[30:31], v35 offset:35328
    v_exp_f32 v68, v68
    v_mul_f32 v72, v136, v140
    v_mfma_f32_32x32x16_bf16 v[240:255], v[116:119], a[52:55], v[240:255]
    s_waitcnt lgkmcnt(12)
    s_add_u32 m0, s89, 16384
    s_nop 0
    buffer_load_dwordx4 v6, s[36:39], s71 offen offset:0 lds
    v_exp_f32 v69, v69
    v_mul_f32 v73, v137, v141
    v_mfma_f32_16x16x32_bf16 v[108:111], v[92:95], v[112:115], v[108:111]
    v_exp_f32 v70, v70
    s_waitcnt lgkmcnt(5)
    v_mfma_f32_32x32x16_bf16 v[192:207], v[120:123], a[56:59], v[192:207]
    ds_read_b64_tr_b16 v[112:113], v30 offset:0
    ds_read_b64_tr_b16 v[114:115], v30 offset:512
    ds_read_b64_tr_b16 v[116:117], v31 offset:0
    ds_read_b64_tr_b16 v[118:119], v31 offset:512
    v_mul_f32 v74, v138, v142
    v_mfma_f32_32x32x16_bf16 v[208:223], v[120:123], a[60:63], v[208:223]
    buffer_load_dwordx4 v7, s[36:39], s71 offen offset:1024 lds
    v_exp_f32 v71, v71
    v_mul_f32 v75, v139, v143
    v_fma_f32 v68, v68, v48, v48
    v_fma_f32 v69, v69, v48, v48
    v_mfma_f32_32x32x16_bf16 v[224:239], v[124:127], a[56:59], v[224:239]
    v_fma_f32 v70, v70, v48, v48
    v_fma_f32 v71, v71, v48, v48
    v_rcp_f32 v68, v68
    v_rcp_f32 v69, v69
    v_mfma_f32_32x32x16_bf16 v[240:255], v[124:127], a[60:63], v[240:255]
    buffer_load_dwordx4 v8, s[36:39], s71 offen offset:2048 lds
    v_rcp_f32 v70, v70
    v_rcp_f32 v71, v71
    v_mul_f32 v72, v72, v68
    v_mfma_f32_16x16x32_bf16 v[108:111], v[92:95], v[120:123], v[108:111]
    v_mul_f32 v73, v73, v69
    v_mul_f32 v74, v74, v70
    s_waitcnt lgkmcnt(0)
    v_mfma_f32_32x32x16_bf16 v[192:207], v[112:115], a[64:67], v[192:207]
    ds_read_b64_tr_b16 v[120:121], v30 offset:2048
    ds_read_b64_tr_b16 v[122:123], v30 offset:2560
    ds_read_b64_tr_b16 v[124:125], v31 offset:2048
    ds_read_b64_tr_b16 v[126:127], v31 offset:2560
    v_mul_f32 v75, v75, v71
    v_cvt_pk_bf16_f32 v130, v72, v73
    v_mfma_f32_32x32x16_bf16 v[208:223], v[112:115], a[68:71], v[208:223]
    buffer_load_dwordx4 v9, s[36:39], s71 offen offset:3072 lds
    s_waitcnt vmcnt(16)
    ds_read_b64_tr_b16 a[32:33], v34 offset:49152
    ds_read_b64_tr_b16 a[34:35], v34 offset:49664
    v_cvt_pk_bf16_f32 v131, v74, v75
    v_mul_f32 v68, v144, v144
    v_mul_f32 v69, v145, v145
    v_mfma_f32_32x32x16_bf16 v[224:239], v[116:119], a[64:67], v[224:239]
    ds_read_b64_tr_b16 a[36:37], v35 offset:49152
    ds_read_b64_tr_b16 a[38:39], v35 offset:49664
    ds_read_b64_tr_b16 a[40:41], v34 offset:51200
    v_mul_f32 v70, v146, v146
    v_mul_f32 v71, v147, v147
    v_fma_f32 v68, v68, v47, v45
    v_mfma_f32_32x32x16_bf16 v[240:255], v[116:119], a[68:71], v[240:255]
    s_add_u32 m0, s89, 32768
    v_fma_f32 v69, v69, v47, v45
    buffer_load_dwordx4 v10, s[40:43], s79 offen offset:0 lds
    v_fma_f32 v70, v70, v47, v45
    v_fma_f32 v71, v71, v47, v45
    v_mul_f32 v68, v144, v68
    v_mfma_f32_16x16x32_bf16 v[108:111], v[92:95], v[112:115], v[108:111]
    v_mul_f32 v69, v145, v69
    v_mul_f32 v70, v146, v70
    s_waitcnt lgkmcnt(5)
    v_mfma_f32_32x32x16_bf16 v[192:207], v[120:123], a[72:75], v[192:207]
    ds_read_b64_tr_b16 v[112:113], v30 offset:4096
    ds_read_b64_tr_b16 v[114:115], v30 offset:4608
    ds_read_b64_tr_b16 v[116:117], v31 offset:4096
    ds_read_b64_tr_b16 v[118:119], v31 offset:4608
    v_mul_f32 v71, v147, v71
    v_mfma_f32_32x32x16_bf16 v[208:223], v[120:123], a[76:79], v[208:223]
    buffer_load_dwordx4 v11, s[40:43], s79 offen offset:1024 lds
    ds_read_b64_tr_b16 a[42:43], v34 offset:51712
    ds_read_b64_tr_b16 a[44:45], v35 offset:51200
    v_exp_f32 v68, v68
    v_mul_f32 v72, v144, v148
    v_mfma_f32_32x32x16_bf16 v[224:239], v[124:127], a[72:75], v[224:239]
    ds_read_b64_tr_b16 a[46:47], v35 offset:51712
    s_waitcnt vmcnt(14)
    ds_read_b64_tr_b16 a[48:49], v36 offset:0
    ds_read_b64_tr_b16 a[50:51], v36 offset:512
    v_exp_f32 v69, v69
    v_mul_f32 v73, v145, v149
    v_mfma_f32_32x32x16_bf16 v[240:255], v[124:127], a[76:79], v[240:255]
    buffer_load_dwordx4 v12, s[40:43], s79 offen offset:2048 lds
    v_exp_f32 v70, v70
    v_mul_f32 v74, v146, v150
    v_exp_f32 v71, v71
    v_mfma_f32_16x16x32_bf16 v[108:111], v[92:95], v[120:123], v[108:111]
    v_mul_f32 v75, v147, v151
    v_fma_f32 v68, v68, v49, v49
    s_waitcnt lgkmcnt(5)
    v_mfma_f32_32x32x16_bf16 v[192:207], v[112:115], a[80:83], v[192:207]
    ds_read_b64_tr_b16 v[120:121], v30 offset:6144
    ds_read_b64_tr_b16 v[122:123], v30 offset:6656
    ds_read_b64_tr_b16 v[124:125], v31 offset:6144
    ds_read_b64_tr_b16 v[126:127], v31 offset:6656
    v_fma_f32 v69, v69, v49, v49
    v_fma_f32 v70, v70, v49, v49
    v_mfma_f32_32x32x16_bf16 v[208:223], v[112:115], a[84:87], v[208:223]
    buffer_load_dwordx4 v13, s[40:43], s79 offen offset:3072 lds
    ds_read_b64_tr_b16 a[52:53], v37 offset:0
    ds_read_b64_tr_b16 a[54:55], v37 offset:512
    v_fma_f32 v71, v71, v49, v49
    v_rcp_f32 v68, v68
    v_mfma_f32_32x32x16_bf16 v[224:239], v[116:119], a[80:83], v[224:239]
    ds_read_b64_tr_b16 a[56:57], v36 offset:2048
    ds_read_b64_tr_b16 a[58:59], v36 offset:2560
    ds_read_b64_tr_b16 a[60:61], v37 offset:2048
    v_rcp_f32 v69, v69
    v_mfma_f32_32x32x16_bf16 v[240:255], v[116:119], a[84:87], v[240:255]
    s_waitcnt lgkmcnt(11)
    s_add_u32 m0, s89, 49152
    s_nop 0
    buffer_load_dwordx4 v10, s[40:43], s80 offen offset:0 lds
    v_rcp_f32 v70, v70
    v_rcp_f32 v71, v71
    v_mfma_f32_16x16x32_bf16 v[108:111], v[92:95], v[112:115], v[108:111]
    v_mul_f32 v72, v72, v68
    v_mul_f32 v73, v73, v69
    s_waitcnt lgkmcnt(5)
    v_mfma_f32_32x32x16_bf16 v[192:207], v[120:123], a[88:91], v[192:207]
    s_waitcnt vmcnt(5)
    s_barrier
    ds_read_b64_tr_b16 v[112:113], v32 offset:32768
    ds_read_b64_tr_b16 v[114:115], v32 offset:33280
    ds_read_b64_tr_b16 v[116:117], v33 offset:32768
    ds_read_b64_tr_b16 v[118:119], v33 offset:33280
    v_mul_f32 v74, v74, v70
    v_mul_f32 v75, v75, v71
    v_mfma_f32_32x32x16_bf16 v[208:223], v[120:123], a[92:95], v[208:223]
    buffer_load_dwordx4 v11, s[40:43], s80 offen offset:1024 lds
    ds_read_b64_tr_b16 a[62:63], v37 offset:2560
    v_cvt_pk_bf16_f32 v144, v72, v73
    v_cvt_pk_bf16_f32 v145, v74, v75
    v_mul_f32 v68, v152, v152
    v_mul_f32 v69, v153, v153
    v_mfma_f32_32x32x16_bf16 v[224:239], v[124:127], a[88:91], v[224:239]
    buffer_load_dwordx4 v12, s[40:43], s80 offen offset:2048 lds
    v_mul_f32 v70, v154, v154
    v_mul_f32 v71, v155, v155
    v_fma_f32 v68, v68, v47, v45
    v_fma_f32 v69, v69, v47, v45
    v_fma_f32 v70, v70, v47, v45
    v_mfma_f32_32x32x16_bf16 v[240:255], v[124:127], a[92:95], v[240:255]
    buffer_load_dwordx4 v13, s[40:43], s80 offen offset:3072 lds
    v_fma_f32 v71, v71, v47, v45
    v_mul_f32 v68, v152, v68
    v_mul_f32 v69, v153, v69
    v_mul_f32 v70, v154, v70
    v_mul_f32 v71, v155, v71
    v_mfma_f32_16x16x32_bf16 v[108:111], v[92:95], v[120:123], v[108:111]
    v_exp_f32 v68, v68
    s_waitcnt lgkmcnt(1)
    v_mfma_f32_32x32x16_bf16 v[192:207], v[112:115], a[96:99], v[192:207]
    ds_read_b64_tr_b16 v[120:121], v32 offset:34816
    ds_read_b64_tr_b16 v[122:123], v32 offset:35328
    ds_read_b64_tr_b16 v[124:125], v33 offset:34816
    ds_read_b64_tr_b16 v[126:127], v33 offset:35328
    v_mul_f32 v72, v152, v156
    v_mfma_f32_32x32x16_bf16 v[208:223], v[112:115], a[100:103], v[208:223]
    s_add_u32 m0, s89, 114688
    s_nop 0
    buffer_load_dwordx4 v6, s[36:39], s72 offen offset:0 lds
    ds_read_b64_tr_b16 a[64:65], v36 offset:16384
    ds_read_b64_tr_b16 a[66:67], v36 offset:16896
    v_exp_f32 v69, v69
    v_mfma_f32_32x32x16_bf16 v[224:239], v[116:119], a[96:99], v[224:239]
    buffer_load_dwordx4 v7, s[36:39], s72 offen offset:1024 lds
    ds_read_b64_tr_b16 a[68:69], v37 offset:16384
    ds_read_b64_tr_b16 a[70:71], v37 offset:16896
    ds_read_b64_tr_b16 a[72:73], v36 offset:18432
    v_mul_f32 v73, v153, v157
    v_mfma_f32_32x32x16_bf16 v[240:255], v[116:119], a[100:103], v[240:255]
    buffer_load_dwordx4 v8, s[36:39], s72 offen offset:2048 lds
    v_exp_f32 v70, v70
    v_mul_f32 v74, v154, v158
    v_exp_f32 v71, v71
    v_mfma_f32_16x16x32_bf16 v[108:111], v[92:95], v[112:115], v[108:111]
    v_mul_f32 v75, v155, v159
    v_fma_f32 v68, v68, v49, v49
    s_waitcnt lgkmcnt(5)
    v_mfma_f32_32x32x16_bf16 v[192:207], v[120:123], a[104:107], v[192:207]
    ds_read_b64_tr_b16 v[112:113], v32 offset:36864
    ds_read_b64_tr_b16 v[114:115], v32 offset:37376
    ds_read_b64_tr_b16 v[116:117], v33 offset:36864
    ds_read_b64_tr_b16 v[118:119], v33 offset:37376
    v_fma_f32 v69, v69, v49, v49
    v_fma_f32 v70, v70, v49, v49
    v_mfma_f32_32x32x16_bf16 v[208:223], v[120:123], a[108:111], v[208:223]
    buffer_load_dwordx4 v9, s[36:39], s72 offen offset:3072 lds
    ds_read_b64_tr_b16 a[74:75], v36 offset:18944
    ds_read_b64_tr_b16 a[76:77], v37 offset:18432
    v_fma_f32 v71, v71, v49, v49
    v_rcp_f32 v68, v68
    v_mfma_f32_32x32x16_bf16 v[224:239], v[124:127], a[104:107], v[224:239]
    s_mov_b32 m0, s89
    s_nop 0
    buffer_load_dwordx4 v6, s[36:39], s73 offen offset:0 lds
    ds_read_b64_tr_b16 a[78:79], v37 offset:18944
    v_rcp_f32 v69, v69
    v_mfma_f32_32x32x16_bf16 v[240:255], v[124:127], a[108:111], v[240:255]
    buffer_load_dwordx4 v7, s[36:39], s73 offen offset:1024 lds
    v_rcp_f32 v70, v70
    v_rcp_f32 v71, v71
    v_mul_f32 v72, v72, v68
    v_mfma_f32_16x16x32_bf16 v[108:111], v[92:95], v[120:123], v[108:111]
    v_mul_f32 v73, v73, v69
    v_mul_f32 v74, v74, v70
    s_waitcnt lgkmcnt(3)
    v_mfma_f32_32x32x16_bf16 v[192:207], v[112:115], a[112:115], v[192:207]
    ds_read_b64_tr_b16 v[120:121], v32 offset:38912
    ds_read_b64_tr_b16 v[122:123], v32 offset:39424
    ds_read_b64_tr_b16 v[124:125], v33 offset:38912
    ds_read_b64_tr_b16 v[126:127], v33 offset:39424
    v_mul_f32 v75, v75, v71
    v_cvt_pk_bf16_f32 v146, v72, v73
    v_mfma_f32_32x32x16_bf16 v[208:223], v[112:115], a[116:119], v[208:223]
    buffer_load_dwordx4 v8, s[36:39], s73 offen offset:2048 lds
    v_cvt_pk_bf16_f32 v147, v74, v75
    v_mul_f32 v68, v160, v160
    v_mul_f32 v69, v161, v161
    v_mul_f32 v70, v162, v162
    v_mul_f32 v71, v163, v163
    v_mfma_f32_32x32x16_bf16 v[224:239], v[116:119], a[112:115], v[224:239]
    buffer_load_dwordx4 v9, s[36:39], s73 offen offset:3072 lds
    v_fma_f32 v68, v68, v46, v44
    v_fma_f32 v69, v69, v46, v44
    v_fma_f32 v70, v70, v46, v44
    v_fma_f32 v71, v71, v46, v44
    v_mul_f32 v68, v160, v68
    v_mfma_f32_32x32x16_bf16 v[240:255], v[116:119], a[116:119], v[240:255]
    s_add_u32 s74, s74, 57344
    s_add_u32 m0, s89, 65536
    v_mul_f32 v69, v161, v69
    buffer_load_dwordx4 v10, s[40:43], s74 offen offset:0 lds
    v_mul_f32 v70, v162, v70
    v_mul_f32 v71, v163, v71
    v_mfma_f32_16x16x32_bf16 v[108:111], v[92:95], v[112:115], v[108:111]
    v_exp_f32 v68, v68
    s_waitcnt lgkmcnt(0)
    v_mfma_f32_32x32x16_bf16 v[192:207], v[120:123], a[120:123], v[192:207]
    ds_read_b64_tr_b16 v[112:113], v30 offset:16384
    ds_read_b64_tr_b16 v[114:115], v30 offset:16896
    ds_read_b64_tr_b16 v[116:117], v31 offset:16384
    ds_read_b64_tr_b16 v[118:119], v31 offset:16896
    v_mul_f32 v72, v160, v164
    v_mfma_f32_32x32x16_bf16 v[208:223], v[120:123], a[124:127], v[208:223]
    buffer_load_dwordx4 v11, s[40:43], s74 offen offset:1024 lds
    v_exp_f32 v69, v69
    v_mul_f32 v73, v161, v165
    v_exp_f32 v70, v70
    v_mfma_f32_32x32x16_bf16 v[224:239], v[124:127], a[120:123], v[224:239]
    v_mul_f32 v74, v162, v166
    v_exp_f32 v71, v71
    v_mul_f32 v75, v163, v167
    v_fma_f32 v68, v68, v48, v48
    v_fma_f32 v69, v69, v48, v48
    v_mfma_f32_32x32x16_bf16 v[240:255], v[124:127], a[124:127], v[240:255]
    buffer_load_dwordx4 v12, s[40:43], s74 offen offset:2048 lds
    v_fma_f32 v70, v70, v48, v48
    v_fma_f32 v71, v71, v48, v48
    v_rcp_f32 v68, v68
    v_mfma_f32_16x16x32_bf16 v[108:111], v[92:95], v[120:123], v[108:111]
    v_rcp_f32 v69, v69
    s_waitcnt lgkmcnt(0)
    v_mfma_f32_32x32x16_bf16 v[192:207], v[112:115], a[128:131], v[192:207]
    ds_read_b64_tr_b16 v[120:121], v30 offset:18432
    ds_read_b64_tr_b16 v[122:123], v30 offset:18944
    ds_read_b64_tr_b16 v[124:125], v31 offset:18432
    ds_read_b64_tr_b16 v[126:127], v31 offset:18944
    v_rcp_f32 v70, v70
    v_mfma_f32_32x32x16_bf16 v[208:223], v[112:115], a[132:135], v[208:223]
    buffer_load_dwordx4 v13, s[40:43], s74 offen offset:3072 lds
    s_waitcnt vmcnt(16)
    ds_read_b64_tr_b16 a[80:81], v34 offset:32768
    ds_read_b64_tr_b16 a[82:83], v34 offset:33280
    v_rcp_f32 v71, v71
    v_mul_f32 v72, v72, v68
    v_mfma_f32_32x32x16_bf16 v[224:239], v[116:119], a[128:131], v[224:239]
    ds_read_b64_tr_b16 a[84:85], v35 offset:32768
    ds_read_b64_tr_b16 a[86:87], v35 offset:33280
    ds_read_b64_tr_b16 a[88:89], v34 offset:34816
    v_mul_f32 v73, v73, v69
    v_mul_f32 v74, v74, v70
    v_mul_f32 v75, v75, v71
    v_mfma_f32_32x32x16_bf16 v[240:255], v[116:119], a[132:135], v[240:255]
    s_add_u32 s75, s75, 57344
    s_add_u32 m0, s89, 81920
    v_cvt_pk_bf16_f32 v160, v72, v73
    buffer_load_dwordx4 v10, s[40:43], s75 offen offset:0 lds
    v_cvt_pk_bf16_f32 v161, v74, v75
    v_mul_f32 v68, v168, v168
    v_mfma_f32_16x16x32_bf16 v[108:111], v[92:95], v[112:115], v[108:111]
    v_mul_f32 v69, v169, v169
    v_mul_f32 v70, v170, v170
    s_waitcnt lgkmcnt(5)
    v_mfma_f32_32x32x16_bf16 v[192:207], v[120:123], a[136:139], v[192:207]
    ds_read_b64_tr_b16 v[112:113], v30 offset:20480
    ds_read_b64_tr_b16 v[114:115], v30 offset:20992
    ds_read_b64_tr_b16 v[116:117], v31 offset:20480
    ds_read_b64_tr_b16 v[118:119], v31 offset:20992
    v_mul_f32 v71, v171, v171
    v_fma_f32 v68, v68, v46, v44
    v_mfma_f32_32x32x16_bf16 v[208:223], v[120:123], a[140:143], v[208:223]
    buffer_load_dwordx4 v11, s[40:43], s75 offen offset:1024 lds
    ds_read_b64_tr_b16 a[90:91], v34 offset:35328
    ds_read_b64_tr_b16 a[92:93], v35 offset:34816
    v_fma_f32 v69, v69, v46, v44
    v_fma_f32 v70, v70, v46, v44
    v_fma_f32 v71, v71, v46, v44
    v_mfma_f32_32x32x16_bf16 v[224:239], v[124:127], a[136:139], v[224:239]
    ds_read_b64_tr_b16 a[94:95], v35 offset:35328
    s_waitcnt vmcnt(14)
    ds_read_b64_tr_b16 a[96:97], v34 offset:49152
    ds_read_b64_tr_b16 a[98:99], v34 offset:49664
    v_mul_f32 v68, v168, v68
    v_mul_f32 v69, v169, v69
    v_mul_f32 v70, v170, v70
    v_mfma_f32_32x32x16_bf16 v[240:255], v[124:127], a[140:143], v[240:255]
    buffer_load_dwordx4 v12, s[40:43], s75 offen offset:2048 lds
    v_mul_f32 v71, v171, v71
    v_exp_f32 v68, v68
    v_mul_f32 v72, v168, v172
    v_mfma_f32_16x16x32_bf16 v[108:111], v[92:95], v[120:123], v[108:111]
    v_exp_f32 v69, v69
    s_waitcnt lgkmcnt(5)
    v_mfma_f32_32x32x16_bf16 v[192:207], v[112:115], a[144:147], v[192:207]
    ds_read_b64_tr_b16 v[120:121], v30 offset:22528
    ds_read_b64_tr_b16 v[122:123], v30 offset:23040
    ds_read_b64_tr_b16 v[124:125], v31 offset:22528
    ds_read_b64_tr_b16 v[126:127], v31 offset:23040
    v_mul_f32 v73, v169, v173
    v_mfma_f32_32x32x16_bf16 v[208:223], v[112:115], a[148:151], v[208:223]
    buffer_load_dwordx4 v13, s[40:43], s75 offen offset:3072 lds
    ds_read_b64_tr_b16 a[100:101], v35 offset:49152
    ds_read_b64_tr_b16 a[102:103], v35 offset:49664
    v_exp_f32 v70, v70
    v_mul_f32 v74, v170, v174
    v_mfma_f32_32x32x16_bf16 v[224:239], v[116:119], a[144:147], v[224:239]
    ds_read_b64_tr_b16 a[104:105], v34 offset:51200
    ds_read_b64_tr_b16 a[106:107], v34 offset:51712
    ds_read_b64_tr_b16 a[108:109], v35 offset:51200
    v_exp_f32 v71, v71
    v_mul_f32 v75, v171, v175
    v_mfma_f32_32x32x16_bf16 v[240:255], v[116:119], a[148:151], v[240:255]
    s_waitcnt lgkmcnt(11)
    s_add_u32 s76, s76, 57344
    s_add_u32 m0, s89, 32768
    v_fma_f32 v68, v68, v48, v48
    buffer_load_dwordx4 v10, s[40:43], s76 offen offset:0 lds
    v_fma_f32 v69, v69, v48, v48
    v_fma_f32 v70, v70, v48, v48
    v_mfma_f32_16x16x32_bf16 v[108:111], v[92:95], v[112:115], v[108:111]
    v_fma_f32 v71, v71, v48, v48
    s_waitcnt lgkmcnt(5)
    v_mfma_f32_32x32x16_bf16 v[192:207], v[120:123], a[152:155], v[192:207]
    s_waitcnt vmcnt(9)
    s_barrier
    ds_read_b64_tr_b16 v[112:113], v32 offset:49152
    ds_read_b64_tr_b16 v[114:115], v32 offset:49664
    ds_read_b64_tr_b16 v[116:117], v33 offset:49152
    ds_read_b64_tr_b16 v[118:119], v33 offset:49664
    v_rcp_f32 v68, v68
    v_mfma_f32_32x32x16_bf16 v[208:223], v[120:123], a[156:159], v[208:223]
    buffer_load_dwordx4 v11, s[40:43], s76 offen offset:1024 lds
    ds_read_b64_tr_b16 a[110:111], v35 offset:51712
    v_rcp_f32 v69, v69
    v_rcp_f32 v70, v70
    v_mfma_f32_32x32x16_bf16 v[224:239], v[124:127], a[152:155], v[224:239]
    v_rcp_f32 v71, v71
    v_mul_f32 v72, v72, v68
    v_mul_f32 v73, v73, v69
    v_mul_f32 v74, v74, v70
    v_mul_f32 v75, v75, v71
    v_mfma_f32_32x32x16_bf16 v[240:255], v[124:127], a[156:159], v[240:255]
    buffer_load_dwordx4 v12, s[40:43], s76 offen offset:2048 lds
    v_cvt_pk_bf16_f32 v162, v72, v73
    v_cvt_pk_bf16_f32 v163, v74, v75
    v_mul_f32 v68, v176, v176
    v_mul_f32 v69, v177, v177
    v_mul_f32 v70, v178, v178
    v_mfma_f32_16x16x32_bf16 v[108:111], v[92:95], v[120:123], v[108:111]
    v_mul_f32 v71, v179, v179
    v_fma_f32 v68, v68, v47, v45
    s_waitcnt lgkmcnt(1)
    v_mfma_f32_32x32x16_bf16 v[192:207], v[112:115], a[160:163], v[192:207]
    ds_read_b64_tr_b16 v[120:121], v32 offset:51200
    ds_read_b64_tr_b16 v[122:123], v32 offset:51712
    ds_read_b64_tr_b16 v[124:125], v33 offset:51200
    ds_read_b64_tr_b16 v[126:127], v33 offset:51712
    v_fma_f32 v69, v69, v47, v45
    v_fma_f32 v70, v70, v47, v45
    v_mfma_f32_32x32x16_bf16 v[208:223], v[112:115], a[164:167], v[208:223]
    buffer_load_dwordx4 v13, s[40:43], s76 offen offset:3072 lds
    v_fma_f32 v71, v71, v47, v45
    v_mul_f32 v68, v176, v68
    v_mul_f32 v69, v177, v69
    v_mul_f32 v70, v178, v70
    v_mul_f32 v71, v179, v71
    v_mfma_f32_32x32x16_bf16 v[224:239], v[116:119], a[160:163], v[224:239]
    v_exp_f32 v68, v68
    v_mul_f32 v72, v176, v180
    v_exp_f32 v69, v69
    v_mul_f32 v73, v177, v181
    v_mfma_f32_32x32x16_bf16 v[240:255], v[116:119], a[164:167], v[240:255]
    s_waitcnt lgkmcnt(4)
    s_add_u32 s77, s77, 57344
    s_add_u32 m0, s89, 49152
    s_nop 0
    buffer_load_dwordx4 v10, s[40:43], s77 offen offset:0 lds
    v_exp_f32 v70, v70
    v_mul_f32 v74, v178, v182
    v_mfma_f32_16x16x32_bf16 v[108:111], v[92:95], v[112:115], v[108:111]
    v_exp_f32 v71, v71
    s_waitcnt lgkmcnt(0)
    v_mfma_f32_32x32x16_bf16 v[192:207], v[120:123], a[168:171], v[192:207]
    ds_read_b64_tr_b16 v[112:113], v32 offset:53248
    ds_read_b64_tr_b16 v[114:115], v32 offset:53760
    ds_read_b64_tr_b16 v[116:117], v33 offset:53248
    ds_read_b64_tr_b16 v[118:119], v33 offset:53760
    v_mul_f32 v75, v179, v183
    v_fma_f32 v68, v68, v49, v49
    v_mfma_f32_32x32x16_bf16 v[208:223], v[120:123], a[172:175], v[208:223]
    buffer_load_dword v6, v29, s[56:59], 0 offen sc1
    v_fma_f32 v69, v69, v49, v49
    v_fma_f32 v70, v70, v49, v49
    v_fma_f32 v71, v71, v49, v49
    v_rcp_f32 v68, v68
    v_mfma_f32_32x32x16_bf16 v[224:239], v[124:127], a[168:171], v[224:239]
    v_rcp_f32 v69, v69
    v_rcp_f32 v70, v70
    v_rcp_f32 v71, v71
    v_mfma_f32_32x32x16_bf16 v[240:255], v[124:127], a[172:175], v[240:255]
    buffer_load_dwordx4 v11, s[40:43], s77 offen offset:1024 lds
    v_mul_f32 v72, v72, v68
    v_mul_f32 v73, v73, v69
    v_mul_f32 v74, v74, v70
    v_mul_f32 v75, v75, v71
    v_cvt_pk_bf16_f32 v176, v72, v73
    v_mfma_f32_16x16x32_bf16 v[108:111], v[92:95], v[120:123], v[108:111]
    v_cvt_pk_bf16_f32 v177, v74, v75
    v_mul_f32 v68, v184, v184
    s_waitcnt lgkmcnt(0)
    v_mfma_f32_32x32x16_bf16 v[192:207], v[112:115], a[176:179], v[192:207]
    ds_read_b64_tr_b16 v[120:121], v32 offset:55296
    ds_read_b64_tr_b16 v[122:123], v32 offset:55808
    ds_read_b64_tr_b16 v[124:125], v33 offset:55296
    ds_read_b64_tr_b16 v[126:127], v33 offset:55808
    v_mul_f32 v69, v185, v185
    v_mul_f32 v70, v186, v186
    v_mfma_f32_32x32x16_bf16 v[208:223], v[112:115], a[180:183], v[208:223]
    buffer_load_dwordx4 v12, s[40:43], s77 offen offset:2048 lds
    v_mul_f32 v71, v187, v187
    v_fma_f32 v68, v68, v47, v45
    v_fma_f32 v69, v69, v47, v45
    v_fma_f32 v70, v70, v47, v45
    v_fma_f32 v71, v71, v47, v45
    v_mfma_f32_32x32x16_bf16 v[224:239], v[116:119], a[176:179], v[224:239]
    v_mul_f32 v68, v184, v68
    v_mul_f32 v69, v185, v69
    v_mul_f32 v70, v186, v70
    v_mul_f32 v71, v187, v71
    v_exp_f32 v68, v68
    v_mfma_f32_32x32x16_bf16 v[240:255], v[116:119], a[180:183], v[240:255]
    buffer_load_dwordx4 v13, s[40:43], s77 offen offset:3072 lds
    v_mul_f32 v72, v184, v188
    v_exp_f32 v69, v69
    v_mul_f32 v73, v185, v189
    v_mfma_f32_16x16x32_bf16 v[108:111], v[92:95], v[112:115], v[108:111]
    v_exp_f32 v70, v70
    s_waitcnt lgkmcnt(0)
    v_mfma_f32_32x32x16_bf16 v[192:207], v[120:123], a[184:187], v[192:207]
    ds_read_b64_tr_b16 v[112:113], v30 offset:0
    ds_read_b64_tr_b16 v[114:115], v30 offset:512
    ds_read_b64_tr_b16 v[116:117], v31 offset:0
    ds_read_b64_tr_b16 v[118:119], v31 offset:512
    v_mul_f32 v74, v186, v190
    v_mfma_f32_32x32x16_bf16 v[208:223], v[120:123], a[188:191], v[208:223]
    v_exp_f32 v71, v71
    v_mul_f32 v75, v187, v191
    v_fma_f32 v68, v68, v49, v49
    v_fma_f32 v69, v69, v49, v49
    v_fma_f32 v70, v70, v49, v49
    v_mfma_f32_32x32x16_bf16 v[224:239], v[124:127], a[184:187], v[224:239]
    v_fma_f32 v71, v71, v49, v49
    v_rcp_f32 v68, v68
    v_rcp_f32 v69, v69
    v_mfma_f32_32x32x16_bf16 v[240:255], v[124:127], a[188:191], v[240:255]
    v_rcp_f32 v70, v70
    v_rcp_f32 v71, v71
    v_mul_f32 v72, v72, v68
    v_mul_f32 v73, v73, v69
    v_mfma_f32_16x16x32_bf16 v[108:111], v[92:95], v[120:123], v[108:111]
    v_mul_f32 v74, v74, v70
    v_mul_f32 v75, v75, v71
    s_waitcnt lgkmcnt(0)
    v_mfma_f32_32x32x16_bf16 v[192:207], v[112:115], a[192:195], v[192:207]
    ds_read_b64_tr_b16 v[120:121], v30 offset:2048
    ds_read_b64_tr_b16 v[122:123], v30 offset:2560
    ds_read_b64_tr_b16 v[124:125], v31 offset:2048
    ds_read_b64_tr_b16 v[126:127], v31 offset:2560
    v_cvt_pk_bf16_f32 v178, v72, v73
    v_cvt_pk_bf16_f32 v179, v74, v75
    v_mfma_f32_32x32x16_bf16 v[208:223], v[112:115], a[196:199], v[208:223]
    buffer_store_dwordx2 v[86:87], v28, s[44:47], 0 offen sc1
    v_mfma_f32_32x32x16_bf16 v[224:239], v[116:119], a[192:195], v[224:239]
    v_mfma_f32_32x32x16_bf16 v[240:255], v[116:119], a[196:199], v[240:255]
    buffer_store_dwordx4 v[128:131], v40, s[44:47], s6 offen sc1
    v_mfma_f32_16x16x32_bf16 v[108:111], v[92:95], v[112:115], v[108:111]
    s_waitcnt lgkmcnt(0)
    v_mfma_f32_32x32x16_bf16 v[192:207], v[120:123], a[200:203], v[192:207]
    ds_read_b64_tr_b16 v[112:113], v30 offset:4096
    ds_read_b64_tr_b16 v[114:115], v30 offset:4608
    ds_read_b64_tr_b16 v[116:117], v31 offset:4096
    ds_read_b64_tr_b16 v[118:119], v31 offset:4608
    v_mfma_f32_32x32x16_bf16 v[208:223], v[120:123], a[204:207], v[208:223]
    buffer_store_dwordx4 v[144:147], v40, s[44:47], s7 offen sc1
    v_mfma_f32_32x32x16_bf16 v[224:239], v[124:127], a[200:203], v[224:239]
    v_mfma_f32_32x32x16_bf16 v[240:255], v[124:127], a[204:207], v[240:255]
    buffer_store_dwordx4 v[160:163], v40, s[44:47], s8 offen sc1
    v_mfma_f32_16x16x32_bf16 v[108:111], v[92:95], v[120:123], v[108:111]
    s_waitcnt lgkmcnt(0)
    v_mfma_f32_32x32x16_bf16 v[192:207], v[112:115], a[208:211], v[192:207]
    ds_read_b64_tr_b16 v[120:121], v30 offset:6144
    ds_read_b64_tr_b16 v[122:123], v30 offset:6656
    ds_read_b64_tr_b16 v[124:125], v31 offset:6144
    ds_read_b64_tr_b16 v[126:127], v31 offset:6656
    v_mfma_f32_32x32x16_bf16 v[208:223], v[112:115], a[212:215], v[208:223]
    buffer_store_dwordx4 v[176:179], v40, s[44:47], s9 offen sc1
    v_mfma_f32_32x32x16_bf16 v[224:239], v[116:119], a[208:211], v[224:239]
    v_mfma_f32_32x32x16_bf16 v[240:255], v[116:119], a[212:215], v[240:255]
    v_mfma_f32_16x16x32_bf16 v[108:111], v[92:95], v[112:115], v[108:111]
    s_waitcnt lgkmcnt(0)
    v_mfma_f32_16x16x32_bf16 v[108:111], v[92:95], v[120:123], v[108:111]
    v_mfma_f32_32x32x16_bf16 v[192:207], v[120:123], a[216:219], v[192:207]
    v_mfma_f32_32x32x16_bf16 v[208:223], v[120:123], a[220:223], v[208:223]
    s_nop 5
    v_cndmask_b32 v108, v108, 0, s[0:1]
    v_cvt_pk_bf16_f32 v100, v108, v108
    v_and_b32 v101, 0xffff0000, v100
    v_sub_f32 v108, v108, v101
    v_cvt_pk_bf16_f32 v102, v108, v108
    v_and_b32 v101, 0xffff0000, v102
    v_mfma_f32_32x32x16_bf16 v[224:239], v[124:127], a[216:219], v[224:239]
    v_sub_f32 v108, v108, v101
    v_and_b32 v100, 0xffff, v100
    v_or_b32 v52, v100, v101
    v_cvt_pk_bf16_f32 v53, v108, 0
    ds_write_b64 v25, v[52:53]
    v_xor_b32 v25, 512, v25
    v_mfma_f32_32x32x16_bf16 v[240:255], v[124:127], a[220:223], v[240:255]
    s_waitcnt lgkmcnt(0)
    v_mfma_f32_32x32x16_bf16 v[192:207], v[52:55], v[60:63], v[192:207]
    s_waitcnt vmcnt(8)
    v_cmp_gt_u32 vcc, s4, v6
    s_cbranch_vccnz L_slow0
L_back0:
    s_barrier
    ds_read_b64 v[56:57], v25
    s_add_u32 s78, s78, 57344
    s_add_u32 m0, s89, 98304
    s_nop 0
    buffer_load_dwordx4 v10, s[40:43], s78 offen offset:0 lds
    s_nop 2
    v_pk_mul_f32 v[96:97], v[192:193], v[192:193]
    v_pk_mul_f32 v[98:99], v[194:195], v[194:195]
    v_pk_mul_f32 v[100:101], v[200:201], v[200:201]
    v_pk_mul_f32 v[102:103], v[202:203], v[202:203]
    v_pk_fma_f32 v[96:97], v[96:97], v[46:47], v[44:45] op_sel:[0,0,0] op_sel_hi:[1,0,0]
    v_pk_fma_f32 v[98:99], v[98:99], v[46:47], v[44:45] op_sel:[0,0,0] op_sel_hi:[1,0,0]
    v_pk_fma_f32 v[100:101], v[100:101], v[46:47], v[44:45] op_sel:[0,0,0] op_sel_hi:[1,0,0]
    v_pk_fma_f32 v[102:103], v[102:103], v[46:47], v[44:45] op_sel:[0,0,0] op_sel_hi:[1,0,0]
    v_pk_mul_f32 v[96:97], v[192:193], v[96:97]
    v_pk_mul_f32 v[98:99], v[194:195], v[98:99]
    v_pk_mul_f32 v[100:101], v[200:201], v[100:101]
    v_pk_mul_f32 v[102:103], v[202:203], v[102:103]
    v_pk_mul_f32 v[104:105], v[192:193], v[196:197]
    v_pk_mul_f32 v[106:107], v[194:195], v[198:199]
    s_sub_u32 s92, s101, 2097152
    buffer_load_dwordx4 a[224:227], v40, s[44:47], s92 offen offset:0 sc1
    v_pk_mul_f32 v[108:109], v[200:201], v[204:205]
    v_pk_mul_f32 v[110:111], v[202:203], v[206:207]
    v_mfma_f32_32x32x16_bf16 v[208:223], v[52:55], v[64:67], v[208:223]
    v_exp_f32 v96, v96
    v_exp_f32 v97, v97
    v_exp_f32 v98, v98
    v_exp_f32 v99, v99
    v_exp_f32 v100, v100
    buffer_load_dwordx4 a[228:231], v40, s[44:47], s92 offen offset:1024 sc1
    v_exp_f32 v101, v101
    v_exp_f32 v102, v102
    v_exp_f32 v103, v103
    v_pk_fma_f32 v[96:97], v[96:97], v[48:49], v[48:49] op_sel:[0,0,0] op_sel_hi:[1,0,0]
    v_pk_fma_f32 v[98:99], v[98:99], v[48:49], v[48:49] op_sel:[0,0,0] op_sel_hi:[1,0,0]
    v_pk_fma_f32 v[100:101], v[100:101], v[48:49], v[48:49] op_sel:[0,0,0] op_sel_hi:[1,0,0]
    v_pk_fma_f32 v[102:103], v[102:103], v[48:49], v[48:49] op_sel:[0,0,0] op_sel_hi:[1,0,0]
    s_waitcnt lgkmcnt(0)
    v_mfma_f32_32x32x16_bf16 v[224:239], v[56:59], v[60:63], v[224:239]
    v_rcp_f32 v96, v96
    buffer_load_dwordx4 v11, s[40:43], s78 offen offset:1024 lds
    v_rcp_f32 v97, v97
    v_rcp_f32 v98, v98
    v_rcp_f32 v99, v99
    v_rcp_f32 v100, v100
    v_rcp_f32 v101, v101
    v_rcp_f32 v102, v102
    buffer_load_dwordx4 v12, s[40:43], s78 offen offset:2048 lds
    v_rcp_f32 v103, v103
    v_pk_mul_f32 v[104:105], v[104:105], v[96:97]
    v_pk_mul_f32 v[106:107], v[106:107], v[98:99]
    v_pk_mul_f32 v[108:109], v[108:109], v[100:101]
    v_pk_mul_f32 v[110:111], v[110:111], v[102:103]
    v_cvt_pk_bf16_f32 v192, v104, v105
    v_cvt_pk_bf16_f32 v193, v106, v107
    v_cvt_pk_bf16_f32 v194, v108, v109
    v_cvt_pk_bf16_f32 v195, v110, v111
    buffer_load_dwordx4 v13, s[40:43], s78 offen offset:3072 lds
    v_pk_mul_f32 v[96:97], v[208:209], v[208:209]
    v_pk_mul_f32 v[98:99], v[210:211], v[210:211]
    v_pk_mul_f32 v[100:101], v[216:217], v[216:217]
    v_pk_mul_f32 v[102:103], v[218:219], v[218:219]
    v_pk_fma_f32 v[96:97], v[96:97], v[46:47], v[44:45] op_sel:[0,1,1] op_sel_hi:[1,1,1]
    v_pk_fma_f32 v[98:99], v[98:99], v[46:47], v[44:45] op_sel:[0,1,1] op_sel_hi:[1,1,1]
    v_pk_fma_f32 v[100:101], v[100:101], v[46:47], v[44:45] op_sel:[0,1,1] op_sel_hi:[1,1,1]
    v_pk_fma_f32 v[102:103], v[102:103], v[46:47], v[44:45] op_sel:[0,1,1] op_sel_hi:[1,1,1]
    v_pk_mul_f32 v[96:97], v[208:209], v[96:97]
    v_pk_mul_f32 v[98:99], v[210:211], v[98:99]
    v_pk_mul_f32 v[100:101], v[216:217], v[100:101]
    v_pk_mul_f32 v[102:103], v[218:219], v[102:103]
    v_pk_mul_f32 v[104:105], v[208:209], v[212:213]
    v_pk_mul_f32 v[106:107], v[210:211], v[214:215]
    s_add_u32 s79, s79, 57344
    s_add_u32 m0, s89, 16384
    s_nop 0
    buffer_load_dwordx4 v10, s[40:43], s79 offen offset:0 lds
    v_pk_mul_f32 v[108:109], v[216:217], v[220:221]
    v_pk_mul_f32 v[110:111], v[218:219], v[222:223]
    v_mfma_f32_32x32x16_bf16 v[240:255], v[56:59], v[64:67], v[240:255]
    v_exp_f32 v96, v96
    v_exp_f32 v97, v97
    v_exp_f32 v98, v98
    v_exp_f32 v99, v99
    v_exp_f32 v100, v100
    buffer_load_dwordx4 v11, s[40:43], s79 offen offset:1024 lds
    v_exp_f32 v101, v101
    v_exp_f32 v102, v102
    v_exp_f32 v103, v103
    v_pk_fma_f32 v[96:97], v[96:97], v[48:49], v[48:49] op_sel:[0,1,1] op_sel_hi:[1,1,1]
    v_pk_fma_f32 v[98:99], v[98:99], v[48:49], v[48:49] op_sel:[0,1,1] op_sel_hi:[1,1,1]
    v_pk_fma_f32 v[100:101], v[100:101], v[48:49], v[48:49] op_sel:[0,1,1] op_sel_hi:[1,1,1]
    v_pk_fma_f32 v[102:103], v[102:103], v[48:49], v[48:49] op_sel:[0,1,1] op_sel_hi:[1,1,1]
    v_rcp_f32 v96, v96
    v_rcp_f32 v97, v97
    buffer_load_dwordx4 v12, s[40:43], s79 offen offset:2048 lds
    v_rcp_f32 v98, v98
    v_rcp_f32 v99, v99
    v_rcp_f32 v100, v100
    v_rcp_f32 v101, v101
    v_rcp_f32 v102, v102
    v_rcp_f32 v103, v103
    v_pk_mul_f32 v[104:105], v[104:105], v[96:97]
    buffer_load_dwordx4 v13, s[40:43], s79 offen offset:3072 lds
    v_pk_mul_f32 v[106:107], v[106:107], v[98:99]
    v_pk_mul_f32 v[108:109], v[108:109], v[100:101]
    v_pk_mul_f32 v[110:111], v[110:111], v[102:103]
    v_cvt_pk_bf16_f32 v208, v104, v105
    v_cvt_pk_bf16_f32 v209, v106, v107
    v_cvt_pk_bf16_f32 v210, v108, v109
    v_cvt_pk_bf16_f32 v211, v110, v111
    s_add_u32 s80, s80, 57344
    s_add_u32 m0, s89, 114688
    s_nop 0
    buffer_load_dwordx4 v10, s[40:43], s80 offen offset:0 lds
    v_pk_mul_f32 v[96:97], v[224:225], v[224:225]
    v_pk_mul_f32 v[98:99], v[226:227], v[226:227]
    v_pk_mul_f32 v[100:101], v[232:233], v[232:233]
    v_pk_mul_f32 v[102:103], v[234:235], v[234:235]
    v_pk_fma_f32 v[96:97], v[96:97], v[46:47], v[44:45] op_sel:[0,0,0] op_sel_hi:[1,0,0]
    v_pk_fma_f32 v[98:99], v[98:99], v[46:47], v[44:45] op_sel:[0,0,0] op_sel_hi:[1,0,0]
    v_pk_fma_f32 v[100:101], v[100:101], v[46:47], v[44:45] op_sel:[0,0,0] op_sel_hi:[1,0,0]
    v_pk_fma_f32 v[102:103], v[102:103], v[46:47], v[44:45] op_sel:[0,0,0] op_sel_hi:[1,0,0]
    v_pk_mul_f32 v[96:97], v[224:225], v[96:97]
    v_pk_mul_f32 v[98:99], v[226:227], v[98:99]
    v_pk_mul_f32 v[100:101], v[232:233], v[100:101]
    v_pk_mul_f32 v[102:103], v[234:235], v[102:103]
    v_pk_mul_f32 v[104:105], v[224:225], v[228:229]
    v_pk_mul_f32 v[106:107], v[226:227], v[230:231]
    s_waitcnt vmcnt(11)
    v_mov_b32 v51, 1
    buffer_store_dword v51, v50, s[44:47], 0 offen sc1
    v_pk_mul_f32 v[108:109], v[232:233], v[236:237]
    v_pk_mul_f32 v[110:111], v[234:235], v[238:239]
    v_exp_f32 v96, v96
    v_exp_f32 v97, v97
    v_exp_f32 v98, v98
    v_exp_f32 v99, v99
    v_exp_f32 v100, v100
    buffer_load_dwordx4 v11, s[40:43], s80 offen offset:1024 lds
    v_exp_f32 v101, v101
    v_exp_f32 v102, v102
    v_exp_f32 v103, v103
    v_pk_fma_f32 v[96:97], v[96:97], v[48:49], v[48:49] op_sel:[0,0,0] op_sel_hi:[1,0,0]
    v_pk_fma_f32 v[98:99], v[98:99], v[48:49], v[48:49] op_sel:[0,0,0] op_sel_hi:[1,0,0]
    v_pk_fma_f32 v[100:101], v[100:101], v[48:49], v[48:49] op_sel:[0,0,0] op_sel_hi:[1,0,0]
    v_pk_fma_f32 v[102:103], v[102:103], v[48:49], v[48:49] op_sel:[0,0,0] op_sel_hi:[1,0,0]
    v_rcp_f32 v96, v96
    v_rcp_f32 v97, v97
    buffer_load_dwordx4 v12, s[40:43], s80 offen offset:2048 lds
    v_rcp_f32 v98, v98
    v_rcp_f32 v99, v99
    v_rcp_f32 v100, v100
    v_rcp_f32 v101, v101
    v_rcp_f32 v102, v102
    v_rcp_f32 v103, v103
    v_pk_mul_f32 v[104:105], v[104:105], v[96:97]
    buffer_load_dwordx4 v13, s[40:43], s80 offen offset:3072 lds
    v_pk_mul_f32 v[106:107], v[106:107], v[98:99]
    v_pk_mul_f32 v[108:109], v[108:109], v[100:101]
    v_pk_mul_f32 v[110:111], v[110:111], v[102:103]
    v_cvt_pk_bf16_f32 v224, v104, v105
    v_cvt_pk_bf16_f32 v225, v106, v107
    v_cvt_pk_bf16_f32 v226, v108, v109
    v_cvt_pk_bf16_f32 v227, v110, v111
    v_pk_mul_f32 v[96:97], v[240:241], v[240:241]
    v_pk_mul_f32 v[98:99], v[242:243], v[242:243]
    v_pk_mul_f32 v[100:101], v[248:249], v[248:249]
    v_pk_mul_f32 v[102:103], v[250:251], v[250:251]
    v_pk_fma_f32 v[96:97], v[96:97], v[46:47], v[44:45] op_sel:[0,1,1] op_sel_hi:[1,1,1]
    v_pk_fma_f32 v[98:99], v[98:99], v[46:47], v[44:45] op_sel:[0,1,1] op_sel_hi:[1,1,1]
    v_pk_fma_f32 v[100:101], v[100:101], v[46:47], v[44:45] op_sel:[0,1,1] op_sel_hi:[1,1,1]
    v_pk_fma_f32 v[102:103], v[102:103], v[46:47], v[44:45] op_sel:[0,1,1] op_sel_hi:[1,1,1]
    v_pk_mul_f32 v[96:97], v[240:241], v[96:97]
    v_pk_mul_f32 v[98:99], v[242:243], v[98:99]
    v_pk_mul_f32 v[100:101], v[248:249], v[100:101]
    v_pk_mul_f32 v[102:103], v[250:251], v[102:103]
    v_pk_mul_f32 v[104:105], v[240:241], v[244:245]
    v_pk_mul_f32 v[106:107], v[242:243], v[246:247]
    v_pk_mul_f32 v[108:109], v[248:249], v[252:253]
    v_pk_mul_f32 v[110:111], v[250:251], v[254:255]
    v_exp_f32 v96, v96
    v_exp_f32 v97, v97
    v_exp_f32 v98, v98
    v_exp_f32 v99, v99
    v_exp_f32 v100, v100
    v_exp_f32 v101, v101
    v_exp_f32 v102, v102
    v_exp_f32 v103, v103
    v_pk_fma_f32 v[96:97], v[96:97], v[48:49], v[48:49] op_sel:[0,1,1] op_sel_hi:[1,1,1]
    v_pk_fma_f32 v[98:99], v[98:99], v[48:49], v[48:49] op_sel:[0,1,1] op_sel_hi:[1,1,1]
    v_pk_fma_f32 v[100:101], v[100:101], v[48:49], v[48:49] op_sel:[0,1,1] op_sel_hi:[1,1,1]
    v_pk_fma_f32 v[102:103], v[102:103], v[48:49], v[48:49] op_sel:[0,1,1] op_sel_hi:[1,1,1]
    v_rcp_f32 v96, v96
    v_rcp_f32 v97, v97
    v_rcp_f32 v98, v98
    v_rcp_f32 v99, v99
    v_rcp_f32 v100, v100
    v_rcp_f32 v101, v101
    v_rcp_f32 v102, v102
    v_rcp_f32 v103, v103
    v_pk_mul_f32 v[104:105], v[104:105], v[96:97]
    v_pk_mul_f32 v[106:107], v[106:107], v[98:99]
    v_pk_mul_f32 v[108:109], v[108:109], v[100:101]
    v_pk_mul_f32 v[110:111], v[110:111], v[102:103]
    v_cvt_pk_bf16_f32 v240, v104, v105
    v_cvt_pk_bf16_f32 v241, v106, v107
    v_cvt_pk_bf16_f32 v242, v108, v109
    v_cvt_pk_bf16_f32 v243, v110, v111
    buffer_store_dwordx4 v[192:195], v42, s[44:47], s6 offen sc1
    buffer_store_dwordx4 v[208:211], v42, s[44:47], s7 offen sc1
    buffer_store_dwordx4 v[224:227], v42, s[44:47], s8 offen sc1
    buffer_store_dwordx4 v[240:243], v42, s[44:47], s9 offen sc1
    s_waitcnt vmcnt(17)
    ds_write_b128 v20, a[224:227] offset:0
    s_waitcnt vmcnt(16)
    ds_write_b128 v20, a[228:231] offset:1024
    s_waitcnt lgkmcnt(0)
    s_barrier
    ds_read_b128 v[220:223], v15 offset:0
    ds_read_b128 v[216:219], v15 offset:512
    ds_read_b128 v[212:215], v15 offset:1024
    ds_read_b128 v[208:211], v15 offset:1536
    ds_read_b128 v[204:207], v15 offset:2048
    ds_read_b128 v[200:203], v15 offset:2560
    ds_read_b128 v[196:199], v15 offset:3072
    ds_read_b128 v[192:195], v15 offset:3584
    ds_read2_b32 v[160:161], v14 offset0:0 offset1:1
    ds_read2_b32 v[162:163], v14 offset0:2 offset1:3
    s_waitcnt lgkmcnt(6)
    v_mfma_f32_16x16x32_bf16 v[156:159], v[16:19], v[220:223], 0
    ds_read2_b32 v[164:165], v14 offset0:128 offset1:129
    ds_read2_b32 v[166:167], v14 offset0:130 offset1:131
    v_mfma_f32_16x16x32_bf16 v[152:155], v[16:19], v[216:219], 0
    ds_read2_b32 v[168:169], v21 offset0:0 offset1:1
    ds_read2_b32 v[170:171], v21 offset0:2 offset1:3
    v_mfma_f32_16x16x32_bf16 v[148:151], v[16:19], v[212:215], 0
    ds_read2_b32 v[172:173], v21 offset0:128 offset1:129
    ds_read2_b32 v[174:175], v21 offset0:130 offset1:131
    v_mfma_f32_16x16x32_bf16 v[144:147], v[16:19], v[208:211], 0
    ds_read2_b32 v[176:177], v22 offset0:0 offset1:1
    ds_read2_b32 v[178:179], v22 offset0:2 offset1:3
    s_waitcnt lgkmcnt(10)
    v_mfma_f32_16x16x32_bf16 v[140:143], v[16:19], v[204:207], 0
    ds_read2_b32 v[180:181], v22 offset0:128 offset1:129
    ds_read2_b32 v[182:183], v22 offset0:130 offset1:131
    v_mfma_f32_16x16x32_bf16 v[136:139], v[16:19], v[200:203], 0
    ds_read2_b32 v[184:185], v23 offset0:0 offset1:1
    ds_read2_b32 v[186:187], v23 offset0:2 offset1:3
    v_mfma_f32_16x16x32_bf16 v[132:135], v[16:19], v[196:199], 0
    ds_read2_b32 v[188:189], v23 offset0:128 offset1:129
    ds_read2_b32 v[190:191], v23 offset0:130 offset1:131
    v_mfma_f32_16x16x32_bf16 v[128:131], v[16:19], v[192:195], 0
    s_waitcnt lgkmcnt(14)
    v_mfma_f32_16x16x32_bf16 v[156:159], v[160:163], v[220:223], v[156:159]
    ds_read_b128 v[220:223], v15 offset:64
    v_mfma_f32_16x16x32_bf16 v[152:155], v[160:163], v[216:219], v[152:155]
    v_mfma_f32_16x16x32_bf16 v[148:151], v[160:163], v[212:215], v[148:151]
    v_mfma_f32_16x16x32_bf16 v[144:147], v[160:163], v[208:211], v[144:147]
    v_mfma_f32_16x16x32_bf16 v[140:143], v[160:163], v[204:207], v[140:143]
    v_mfma_f32_16x16x32_bf16 v[136:139], v[160:163], v[200:203], v[136:139]
    v_mfma_f32_16x16x32_bf16 v[132:135], v[160:163], v[196:199], v[132:135]
    v_mfma_f32_16x16x32_bf16 v[128:131], v[160:163], v[192:195], v[128:131]
    ds_read2_b32 v[160:161], v14 offset0:16 offset1:17
    ds_read2_b32 v[162:163], v14 offset0:18 offset1:19
    s_waitcnt lgkmcnt(3)
    v_mfma_f32_16x16x32_bf16 v[156:159], v[164:167], v[216:219], v[156:159]
    ds_read_b128 v[216:219], v15 offset:576
    v_mfma_f32_16x16x32_bf16 v[152:155], v[164:167], v[212:215], v[152:155]
    buffer_load_dword v254, v5, s[44:47], 0 offen sc1
    v_mfma_f32_16x16x32_bf16 v[148:151], v[164:167], v[208:211], v[148:151]
    v_mfma_f32_16x16x32_bf16 v[144:147], v[164:167], v[204:207], v[144:147]
    v_mfma_f32_16x16x32_bf16 v[140:143], v[164:167], v[200:203], v[140:143]
    v_mfma_f32_16x16x32_bf16 v[136:139], v[164:167], v[196:199], v[136:139]
    v_mfma_f32_16x16x32_bf16 v[132:135], v[164:167], v[192:195], v[132:135]
    ds_read2_b32 v[164:165], v14 offset0:144 offset1:145
    ds_read2_b32 v[166:167], v14 offset0:146 offset1:147
    v_mfma_f32_16x16x32_bf16 v[156:159], v[168:171], v[212:215], v[156:159]
    ds_read_b128 v[212:215], v15 offset:1088
    v_mfma_f32_16x16x32_bf16 v[152:155], v[168:171], v[208:211], v[152:155]
    buffer_load_dword v3, v29, s[56:59], 0 offen sc1
    v_mfma_f32_16x16x32_bf16 v[148:151], v[168:171], v[204:207], v[148:151]
    v_mfma_f32_16x16x32_bf16 v[144:147], v[168:171], v[200:203], v[144:147]
    v_mfma_f32_16x16x32_bf16 v[140:143], v[168:171], v[196:199], v[140:143]
    v_mfma_f32_16x16x32_bf16 v[136:139], v[168:171], v[192:195], v[136:139]
    ds_read2_b32 v[168:169], v21 offset0:16 offset1:17
    ds_read2_b32 v[170:171], v21 offset0:18 offset1:19
    v_mfma_f32_16x16x32_bf16 v[156:159], v[172:175], v[208:211], v[156:159]
    ds_read_b128 v[208:211], v15 offset:1600
    v_mfma_f32_16x16x32_bf16 v[152:155], v[172:175], v[204:207], v[152:155]
    v_mfma_f32_16x16x32_bf16 v[148:151], v[172:175], v[200:203], v[148:151]
    v_mfma_f32_16x16x32_bf16 v[144:147], v[172:175], v[196:199], v[144:147]
    v_mfma_f32_16x16x32_bf16 v[140:143], v[172:175], v[192:195], v[140:143]
    ds_read2_b32 v[172:173], v21 offset0:144 offset1:145
    ds_read2_b32 v[174:175], v21 offset0:146 offset1:147
    v_mfma_f32_16x16x32_bf16 v[156:159], v[176:179], v[204:207], v[156:159]
    ds_read_b128 v[204:207], v15 offset:2112
    v_mfma_f32_16x16x32_bf16 v[152:155], v[176:179], v[200:203], v[152:155]
    v_mfma_f32_16x16x32_bf16 v[148:151], v[176:179], v[196:199], v[148:151]
    v_mfma_f32_16x16x32_bf16 v[144:147], v[176:179], v[192:195], v[144:147]
    ds_read2_b32 v[176:177], v22 offset0:16 offset1:17
    ds_read2_b32 v[178:179], v22 offset0:18 offset1:19
    v_mfma_f32_16x16x32_bf16 v[156:159], v[180:183], v[200:203], v[156:159]
    ds_read_b128 v[200:203], v15 offset:2624
    v_mfma_f32_16x16x32_bf16 v[152:155], v[180:183], v[196:199], v[152:155]
    v_mfma_f32_16x16x32_bf16 v[148:151], v[180:183], v[192:195], v[148:151]
    ds_read2_b32 v[180:181], v22 offset0:144 offset1:145
    ds_read2_b32 v[182:183], v22 offset0:146 offset1:147
    v_mfma_f32_16x16x32_bf16 v[156:159], v[184:187], v[196:199], v[156:159]
    ds_read_b128 v[196:199], v15 offset:3136
    v_mfma_f32_16x16x32_bf16 v[152:155], v[184:187], v[192:195], v[152:155]
    ds_read2_b32 v[184:185], v23 offset0:16 offset1:17
    ds_read2_b32 v[186:187], v23 offset0:18 offset1:19
    v_mfma_f32_16x16x32_bf16 v[156:159], v[188:191], v[192:195], v[156:159]
    ds_read_b128 v[192:195], v15 offset:3648
    ds_read2_b32 v[188:189], v23 offset0:144 offset1:145
    ds_read2_b32 v[190:191], v23 offset0:146 offset1:147
    s_waitcnt lgkmcnt(11)
    v_mfma_f32_16x16x32_bf16 v[156:159], v[160:163], v[220:223], v[156:159]
    ds_read_b128 v[220:223], v15 offset:128
    v_mfma_f32_16x16x32_bf16 v[152:155], v[160:163], v[216:219], v[152:155]
    v_mfma_f32_16x16x32_bf16 v[148:151], v[160:163], v[212:215], v[148:151]
    v_mfma_f32_16x16x32_bf16 v[144:147], v[160:163], v[208:211], v[144:147]
    v_mfma_f32_16x16x32_bf16 v[140:143], v[160:163], v[204:207], v[140:143]
    s_waitcnt lgkmcnt(6)
    v_mfma_f32_16x16x32_bf16 v[136:139], v[160:163], v[200:203], v[136:139]
    v_mfma_f32_16x16x32_bf16 v[132:135], v[160:163], v[196:199], v[132:135]
    s_waitcnt lgkmcnt(1)
    v_mfma_f32_16x16x32_bf16 v[128:131], v[160:163], v[192:195], v[128:131]
    ds_read2_b32 v[160:161], v14 offset0:32 offset1:33
    ds_read2_b32 v[162:163], v14 offset0:34 offset1:35
    v_mfma_f32_16x16x32_bf16 v[156:159], v[164:167], v[216:219], v[156:159]
    ds_read_b128 v[216:219], v15 offset:640
    v_mfma_f32_16x16x32_bf16 v[152:155], v[164:167], v[212:215], v[152:155]
    v_mfma_f32_16x16x32_bf16 v[148:151], v[164:167], v[208:211], v[148:151]
    v_mfma_f32_16x16x32_bf16 v[144:147], v[164:167], v[204:207], v[144:147]
    v_mfma_f32_16x16x32_bf16 v[140:143], v[164:167], v[200:203], v[140:143]
    s_waitcnt vmcnt(1)
    v_cmp_gt_u32 vcc, s4, v254
    s_cbranch_vccnz L_slow1
L_back1:
    s_barrier
    buffer_load_dwordx4 a[112:115], v40, s[44:47], s81 offen offset:0 sc1
    v_mfma_f32_16x16x32_bf16 v[136:139], v[164:167], v[196:199], v[136:139]
    v_mfma_f32_16x16x32_bf16 v[132:135], v[164:167], v[192:195], v[132:135]
    ds_read2_b32 v[164:165], v14 offset0:160 offset1:161
    ds_read2_b32 v[166:167], v14 offset0:162 offset1:163
    v_mfma_f32_16x16x32_bf16 v[156:159], v[168:171], v[212:215], v[156:159]
    ds_read_b128 v[212:215], v15 offset:1152
    v_mfma_f32_16x16x32_bf16 v[152:155], v[168:171], v[208:211], v[152:155]
    buffer_load_dwordx4 a[116:119], v41, s[44:47], s81 offen offset:0 sc1
    v_mfma_f32_16x16x32_bf16 v[148:151], v[168:171], v[204:207], v[148:151]
    v_mfma_f32_16x16x32_bf16 v[144:147], v[168:171], v[200:203], v[144:147]
    v_mfma_f32_16x16x32_bf16 v[140:143], v[168:171], v[196:199], v[140:143]
    buffer_load_dwordx4 a[120:123], v40, s[44:47], s81 offen offset:1024 sc1
    v_mfma_f32_16x16x32_bf16 v[136:139], v[168:171], v[192:195], v[136:139]
    ds_read2_b32 v[168:169], v21 offset0:32 offset1:33
    ds_read2_b32 v[170:171], v21 offset0:34 offset1:35
    v_mfma_f32_16x16x32_bf16 v[156:159], v[172:175], v[208:211], v[156:159]
    ds_read_b128 v[208:211], v15 offset:1664
    v_mfma_f32_16x16x32_bf16 v[152:155], v[172:175], v[204:207], v[152:155]
    buffer_load_dwordx4 a[124:127], v41, s[44:47], s81 offen offset:1024 sc1
    v_mfma_f32_16x16x32_bf16 v[148:151], v[172:175], v[200:203], v[148:151]
    v_mfma_f32_16x16x32_bf16 v[144:147], v[172:175], v[196:199], v[144:147]
    v_mfma_f32_16x16x32_bf16 v[140:143], v[172:175], v[192:195], v[140:143]
    ds_read2_b32 v[172:173], v21 offset0:160 offset1:161
    ds_read2_b32 v[174:175], v21 offset0:162 offset1:163
    v_mfma_f32_16x16x32_bf16 v[156:159], v[176:179], v[204:207], v[156:159]
    ds_read_b128 v[204:207], v15 offset:2176
    v_mfma_f32_16x16x32_bf16 v[152:155], v[176:179], v[200:203], v[152:155]
    buffer_load_dwordx4 a[128:131], v40, s[44:47], s82 offen offset:0 sc1
    v_mfma_f32_16x16x32_bf16 v[148:151], v[176:179], v[196:199], v[148:151]
    v_mfma_f32_16x16x32_bf16 v[144:147], v[176:179], v[192:195], v[144:147]
    ds_read2_b32 v[176:177], v22 offset0:32 offset1:33
    ds_read2_b32 v[178:179], v22 offset0:34 offset1:35
    v_mfma_f32_16x16x32_bf16 v[156:159], v[180:183], v[200:203], v[156:159]
    ds_read_b128 v[200:203], v15 offset:2688
    v_mfma_f32_16x16x32_bf16 v[152:155], v[180:183], v[196:199], v[152:155]
    buffer_load_dwordx4 a[132:135], v41, s[44:47], s82 offen offset:0 sc1
    v_mfma_f32_16x16x32_bf16 v[148:151], v[180:183], v[192:195], v[148:151]
    ds_read2_b32 v[180:181], v22 offset0:160 offset1:161
    ds_read2_b32 v[182:183], v22 offset0:162 offset1:163
    v_mfma_f32_16x16x32_bf16 v[156:159], v[184:187], v[196:199], v[156:159]
    ds_read_b128 v[196:199], v15 offset:3200
    v_mfma_f32_16x16x32_bf16 v[152:155], v[184:187], v[192:195], v[152:155]
    ds_read2_b32 v[184:185], v23 offset0:32 offset1:33
    ds_read2_b32 v[186:187], v23 offset0:34 offset1:35
    v_mfma_f32_16x16x32_bf16 v[156:159], v[188:191], v[192:195], v[156:159]
    ds_read_b128 v[192:195], v15 offset:3712
    ds_read2_b32 v[188:189], v23 offset0:160 offset1:161
    ds_read2_b32 v[190:191], v23 offset0:162 offset1:163
    s_waitcnt lgkmcnt(11)
    v_mfma_f32_16x16x32_bf16 v[156:159], v[160:163], v[220:223], v[156:159]
    ds_read_b128 v[220:223], v15 offset:192
    v_mfma_f32_16x16x32_bf16 v[152:155], v[160:163], v[216:219], v[152:155]
    buffer_load_dwordx4 a[136:139], v40, s[44:47], s82 offen offset:1024 sc1
    v_mfma_f32_16x16x32_bf16 v[148:151], v[160:163], v[212:215], v[148:151]
    v_lshrrev_b32 v124, 3, v1
    v_and_b32 v125, 7, v1
    v_mfma_f32_16x16x32_bf16 v[144:147], v[160:163], v[208:211], v[144:147]
    s_lshl3_add_u32 s95, s10, s88
    s_lshl_b32 s95, s95, 3
    v_mfma_f32_16x16x32_bf16 v[140:143], v[160:163], v[204:207], v[140:143]
    buffer_load_dwordx4 a[140:143], v41, s[44:47], s82 offen offset:1024 sc1
    s_waitcnt lgkmcnt(6)
    v_mfma_f32_16x16x32_bf16 v[136:139], v[160:163], v[200:203], v[136:139]
    v_add_u32 v234, s95, v124
    v_mul_u32_u24 v30, 896, v234
    v_mfma_f32_16x16x32_bf16 v[132:135], v[160:163], v[196:199], v[132:135]
    s_lshl_b32 s96, s11, 7
    v_lshl_add_u32 v30, v125, 4, v30
    s_waitcnt lgkmcnt(1)
    v_mfma_f32_16x16x32_bf16 v[128:131], v[160:163], v[192:195], v[128:131]
    ds_read2_b32 v[160:161], v14 offset0:48 offset1:49
    ds_read2_b32 v[162:163], v14 offset0:50 offset1:51
    v_mfma_f32_16x16x32_bf16 v[156:159], v[164:167], v[216:219], v[156:159]
    ds_read_b128 v[216:219], v15 offset:704
    v_mfma_f32_16x16x32_bf16 v[152:155], v[164:167], v[212:215], v[152:155]
    buffer_load_dwordx4 a[144:147], v40, s[44:47], s83 offen offset:0 sc1
    v_mfma_f32_16x16x32_bf16 v[148:151], v[164:167], v[208:211], v[148:151]
    v_add_u32 v30, s96, v30
    v_add_u32 v31, 28672, v30
    v_mfma_f32_16x16x32_bf16 v[144:147], v[164:167], v[204:207], v[144:147]
    v_lshlrev_b32 v234, 3, v234
    v_add_u32 v234, 7340032, v234
    v_mfma_f32_16x16x32_bf16 v[140:143], v[164:167], v[200:203], v[140:143]
    buffer_load_dwordx2 v[120:121], v234, s[44:47], 0 offen offset:0 sc1
    v_mfma_f32_16x16x32_bf16 v[136:139], v[164:167], v[196:199], v[136:139]
    v_mfma_f32_16x16x32_bf16 v[132:135], v[164:167], v[192:195], v[132:135]
    ds_read2_b32 v[164:165], v14 offset0:176 offset1:177
    ds_read2_b32 v[166:167], v14 offset0:178 offset1:179
    v_mfma_f32_16x16x32_bf16 v[156:159], v[168:171], v[212:215], v[156:159]
    ds_read_b128 v[212:215], v15 offset:1216
    v_mfma_f32_16x16x32_bf16 v[152:155], v[168:171], v[208:211], v[152:155]
    buffer_load_dwordx2 v[122:123], v234, s[44:47], 0 offen offset:256 sc1
    v_mfma_f32_16x16x32_bf16 v[148:151], v[168:171], v[204:207], v[148:151]
    v_mfma_f32_16x16x32_bf16 v[144:147], v[168:171], v[200:203], v[144:147]
    v_mfma_f32_16x16x32_bf16 v[140:143], v[168:171], v[196:199], v[140:143]
    buffer_load_dwordx4 v[112:115], v30, s[32:35], 0 offen
    v_mfma_f32_16x16x32_bf16 v[136:139], v[168:171], v[192:195], v[136:139]
    ds_read2_b32 v[168:169], v21 offset0:48 offset1:49
    ds_read2_b32 v[170:171], v21 offset0:50 offset1:51
    v_mfma_f32_16x16x32_bf16 v[156:159], v[172:175], v[208:211], v[156:159]
    ds_read_b128 v[208:211], v15 offset:1728
    v_mfma_f32_16x16x32_bf16 v[152:155], v[172:175], v[204:207], v[152:155]
    buffer_load_dwordx4 v[116:119], v31, s[32:35], 0 offen
    v_mfma_f32_16x16x32_bf16 v[148:151], v[172:175], v[200:203], v[148:151]
    v_add_u32 v6, s89, v40
    v_xor_b32 v7, 4096, v6
    v_mfma_f32_16x16x32_bf16 v[144:147], v[172:175], v[196:199], v[144:147]
    s_cmp_eq_u32 s97, 1
    s_cselect_b64 s[16:17], -1, 0
    v_mfma_f32_16x16x32_bf16 v[140:143], v[172:175], v[192:195], v[140:143]
    ds_read2_b32 v[172:173], v21 offset0:176 offset1:177
    ds_read2_b32 v[174:175], v21 offset0:178 offset1:179
    v_mfma_f32_16x16x32_bf16 v[156:159], v[176:179], v[204:207], v[156:159]
    ds_read_b128 v[204:207], v15 offset:2240
    v_mfma_f32_16x16x32_bf16 v[152:155], v[176:179], v[200:203], v[152:155]
    buffer_store_dword v51, v50, s[44:47], s14 offen sc1
    v_mfma_f32_16x16x32_bf16 v[148:151], v[176:179], v[196:199], v[148:151]
    v_and_b32 v8, 15, v1
    v_lshrrev_b32 v9, 4, v1
    v_mfma_f32_16x16x32_bf16 v[144:147], v[176:179], v[192:195], v[144:147]
    ds_read2_b32 v[176:177], v22 offset0:48 offset1:49
    ds_read2_b32 v[178:179], v22 offset0:50 offset1:51
    v_mfma_f32_16x16x32_bf16 v[156:159], v[180:183], v[200:203], v[156:159]
    ds_read_b128 v[200:203], v15 offset:2752
    v_mfma_f32_16x16x32_bf16 v[152:155], v[180:183], v[196:199], v[152:155]
    buffer_load_dwordx4 a[148:151], v41, s[44:47], s83 offen offset:0 sc1
    v_mfma_f32_16x16x32_bf16 v[148:151], v[180:183], v[192:195], v[148:151]
    ds_read2_b32 v[180:181], v22 offset0:176 offset1:177
    ds_read2_b32 v[182:183], v22 offset0:178 offset1:179
    v_mfma_f32_16x16x32_bf16 v[156:159], v[184:187], v[196:199], v[156:159]
    ds_read_b128 v[196:199], v15 offset:3264
    v_mfma_f32_16x16x32_bf16 v[152:155], v[184:187], v[192:195], v[152:155]
    ds_read2_b32 v[184:185], v23 offset0:48 offset1:49
    ds_read2_b32 v[186:187], v23 offset0:50 offset1:51
    v_mfma_f32_16x16x32_bf16 v[156:159], v[188:191], v[192:195], v[156:159]
    ds_read_b128 v[192:195], v15 offset:3776
    ds_read2_b32 v[188:189], v23 offset0:176 offset1:177
    ds_read2_b32 v[190:191], v23 offset0:178 offset1:179
    s_waitcnt lgkmcnt(11)
    v_mfma_f32_16x16x32_bf16 v[156:159], v[160:163], v[220:223], v[156:159]
    buffer_load_dwordx4 a[152:155], v40, s[44:47], s83 offen offset:1024 sc1
    v_mfma_f32_16x16x32_bf16 v[156:159], v[164:167], v[216:219], v[156:159]
    v_lshlrev_b32 v9, 3, v9
    v_lshl_add_u32 v8, v8, 5, v9
    s_waitcnt vmcnt(16)
    v_mfma_f32_16x16x32_bf16 v[156:159], v[168:171], v[212:215], v[156:159]
    v_cmp_gt_u32 vcc, s5, v3
    s_cbranch_vccnz L_slow3
L_back3:
    v_mfma_f32_16x16x32_bf16 v[156:159], v[172:175], v[208:211], v[156:159]
    buffer_load_dwordx4 a[156:159], v41, s[44:47], s83 offen offset:1024 sc1
    s_waitcnt lgkmcnt(9)
    v_mfma_f32_16x16x32_bf16 v[156:159], v[176:179], v[204:207], v[156:159]
    s_waitcnt lgkmcnt(5)
    v_mfma_f32_16x16x32_bf16 v[156:159], v[180:183], v[200:203], v[156:159]
    s_waitcnt lgkmcnt(3)
    v_mfma_f32_16x16x32_bf16 v[156:159], v[184:187], v[196:199], v[156:159]
    buffer_load_dwordx4 a[160:163], v40, s[44:47], s84 offen offset:0 sc1
    s_waitcnt lgkmcnt(0)
    v_mfma_f32_16x16x32_bf16 v[156:159], v[188:191], v[192:195], v[156:159]
    v_mfma_f32_16x16x32_bf16 v[140:143], v[160:163], v[204:207], v[140:143]
    v_mfma_f32_16x16x32_bf16 v[140:143], v[164:167], v[200:203], v[140:143]
    buffer_load_dwordx4 a[164:167], v41, s[44:47], s84 offen offset:0 sc1
    v_mfma_f32_16x16x32_bf16 v[140:143], v[168:171], v[196:199], v[140:143]
    v_mfma_f32_16x16x32_bf16 v[140:143], v[172:175], v[192:195], v[140:143]
    v_mfma_f32_16x16x32_bf16 v[152:155], v[160:163], v[216:219], v[152:155]
    buffer_load_dwordx4 a[168:171], v40, s[44:47], s84 offen offset:1024 sc1
    v_mfma_f32_16x16x32_bf16 v[152:155], v[164:167], v[212:215], v[152:155]
    v_mfma_f32_16x16x32_bf16 v[152:155], v[168:171], v[208:211], v[152:155]
    v_mfma_f32_16x16x32_bf16 v[152:155], v[172:175], v[204:207], v[152:155]
    buffer_load_dwordx4 a[172:175], v41, s[44:47], s84 offen offset:1024 sc1
    v_mfma_f32_16x16x32_bf16 v[152:155], v[176:179], v[200:203], v[152:155]
    s_nop 0
    v_cndmask_b32 v236, v156, v140, s[16:17]
    v_cndmask_b32 v140, v140, v156, s[16:17]
    v_mfma_f32_16x16x32_bf16 v[152:155], v[180:183], v[196:199], v[152:155]
    v_cndmask_b32 v237, v157, v141, s[16:17]
    v_cndmask_b32 v141, v141, v157, s[16:17]
    v_mfma_f32_16x16x32_bf16 v[152:155], v[184:187], v[192:195], v[152:155]
    buffer_load_dwordx4 a[176:179], v40, s[44:47], s85 offen offset:0 sc1
    v_mfma_f32_16x16x32_bf16 v[136:139], v[160:163], v[200:203], v[136:139]
    v_cndmask_b32 v238, v158, v142, s[16:17]
    v_cndmask_b32 v142, v142, v158, s[16:17]
    v_mfma_f32_16x16x32_bf16 v[136:139], v[164:167], v[196:199], v[136:139]
    v_cndmask_b32 v239, v159, v143, s[16:17]
    v_cndmask_b32 v143, v143, v159, s[16:17]
    v_mfma_f32_16x16x32_bf16 v[136:139], v[168:171], v[192:195], v[136:139]
    buffer_load_dwordx4 a[180:183], v41, s[44:47], s85 offen offset:0 sc1
    v_mfma_f32_16x16x32_bf16 v[148:151], v[160:163], v[212:215], v[148:151]
    ds_write_b128 v6, v[236:239] offset:3072
    v_mfma_f32_16x16x32_bf16 v[148:151], v[164:167], v[208:211], v[148:151]
    v_mfma_f32_16x16x32_bf16 v[148:151], v[168:171], v[204:207], v[148:151]
    buffer_load_dwordx4 a[184:187], v40, s[44:47], s85 offen offset:1024 sc1
    v_mfma_f32_16x16x32_bf16 v[148:151], v[172:175], v[200:203], v[148:151]
    v_mfma_f32_16x16x32_bf16 v[148:151], v[176:179], v[196:199], v[148:151]
    v_cndmask_b32 v232, v152, v136, s[16:17]
    v_cndmask_b32 v136, v136, v152, s[16:17]
    v_mfma_f32_16x16x32_bf16 v[148:151], v[180:183], v[192:195], v[148:151]
    buffer_load_dwordx4 a[188:191], v41, s[44:47], s85 offen offset:1024 sc1
    v_mfma_f32_16x16x32_bf16 v[132:135], v[160:163], v[196:199], v[132:135]
    v_cndmask_b32 v233, v153, v137, s[16:17]
    v_cndmask_b32 v137, v137, v153, s[16:17]
    v_mfma_f32_16x16x32_bf16 v[132:135], v[164:167], v[192:195], v[132:135]
    v_cndmask_b32 v234, v154, v138, s[16:17]
    v_cndmask_b32 v138, v138, v154, s[16:17]
    v_mfma_f32_16x16x32_bf16 v[144:147], v[160:163], v[208:211], v[144:147]
    buffer_load_dwordx4 a[192:195], v40, s[44:47], s86 offen offset:0 sc1
    v_mfma_f32_16x16x32_bf16 v[144:147], v[164:167], v[204:207], v[144:147]
    v_cndmask_b32 v235, v155, v139, s[16:17]
    v_cndmask_b32 v139, v139, v155, s[16:17]
    v_mfma_f32_16x16x32_bf16 v[144:147], v[168:171], v[200:203], v[144:147]
    ds_write_b128 v6, v[232:235] offset:2048
    v_mfma_f32_16x16x32_bf16 v[144:147], v[172:175], v[196:199], v[144:147]
    buffer_load_dwordx4 a[196:199], v41, s[44:47], s86 offen offset:0 sc1
    v_mfma_f32_16x16x32_bf16 v[144:147], v[176:179], v[192:195], v[144:147]
    v_cndmask_b32 v228, v148, v132, s[16:17]
    v_cndmask_b32 v132, v132, v148, s[16:17]
    v_mfma_f32_16x16x32_bf16 v[128:131], v[160:163], v[192:195], v[128:131]
    v_cndmask_b32 v229, v149, v133, s[16:17]
    v_cndmask_b32 v133, v133, v149, s[16:17]
    s_waitcnt vmcnt(23)
    v_mfma_f32_32x32x16_bf16 v[160:175], a[0:3], a[112:115], 0
    v_cndmask_b32 v230, v150, v134, s[16:17]
    v_cndmask_b32 v134, v134, v150, s[16:17]
    v_cndmask_b32 v231, v151, v135, s[16:17]
    v_cndmask_b32 v135, v135, v151, s[16:17]
    ds_write_b128 v6, v[228:231] offset:1024
    v_mfma_f32_32x32x16_bf16 v[192:207], a[0:3], a[116:119], 0
    buffer_load_dwordx4 a[200:203], v40, s[44:47], s86 offen offset:1024 sc1
    v_cndmask_b32 v224, v144, v128, s[16:17]
    v_cndmask_b32 v128, v128, v144, s[16:17]
    v_cndmask_b32 v225, v145, v129, s[16:17]
    v_cndmask_b32 v129, v129, v145, s[16:17]
    v_cndmask_b32 v226, v146, v130, s[16:17]
    v_mfma_f32_32x32x16_bf16 v[176:191], a[4:7], a[112:115], 0
    v_cndmask_b32 v130, v130, v146, s[16:17]
    v_cndmask_b32 v227, v147, v131, s[16:17]
    v_cndmask_b32 v131, v131, v147, s[16:17]
    ds_write_b128 v6, v[224:227] offset:0
    v_mfma_f32_32x32x16_bf16 v[208:223], a[4:7], a[116:119], 0
    buffer_load_dwordx4 a[204:207], v41, s[44:47], s86 offen offset:1024 sc1
    s_waitcnt lgkmcnt(0)
    s_barrier
    ds_read_b128 v[224:227], v7 offset:0
    ds_read_b128 v[228:231], v7 offset:1024
    ds_read_b128 v[232:235], v7 offset:2048
    ds_read_b128 v[236:239], v7 offset:3072
    v_mfma_f32_32x32x16_bf16 v[160:175], a[8:11], a[120:123], v[160:175]
    v_mfma_f32_32x32x16_bf16 v[192:207], a[8:11], a[124:127], v[192:207]
    buffer_load_dword v4, v5, s[44:47], s14 offen sc1
    v_mfma_f32_32x32x16_bf16 v[176:191], a[12:15], a[120:123], v[176:191]
    s_waitcnt lgkmcnt(3)
    v_add_f32 v128, v128, v224
    v_add_f32 v129, v129, v225
    v_add_f32 v130, v130, v226
    v_add_f32 v131, v131, v227
    v_cvt_pk_bf16_f32 v144, v128, v129
    v_cvt_pk_bf16_f32 v145, v130, v131
    v_mfma_f32_32x32x16_bf16 v[208:223], a[12:15], a[124:127], v[208:223]
    buffer_load_dwordx4 a[208:211], v40, s[44:47], s87 offen offset:0 sc1
    v_min_u32 v144, -2, v144
    buffer_store_dwordx2 v[144:145], v8, s[44:47], s101 offen offset:0 sc1
    s_waitcnt lgkmcnt(2)
    v_add_f32 v132, v132, v228
    v_add_f32 v133, v133, v229
    s_waitcnt vmcnt(24)
    v_mfma_f32_32x32x16_bf16 v[160:175], a[16:19], a[128:131], v[160:175]
    ds_read_b64_tr_b16 a[0:1], v36 offset:0
    ds_read_b64_tr_b16 a[2:3], v36 offset:512
    v_add_f32 v134, v134, v230
    v_add_f32 v135, v135, v231
    v_cvt_pk_bf16_f32 v146, v132, v133
    v_cvt_pk_bf16_f32 v147, v134, v135
    v_mfma_f32_32x32x16_bf16 v[192:207], a[16:19], a[132:135], v[192:207]
    buffer_load_dwordx4 a[212:215], v41, s[44:47], s87 offen offset:0 sc1
    v_min_u32 v146, -2, v146
    buffer_store_dwordx2 v[146:147], v8, s[44:47], s101 offen offset:512 sc1
    s_waitcnt lgkmcnt(3)
    v_add_f32 v136, v136, v232
    v_add_f32 v137, v137, v233
    v_mfma_f32_32x32x16_bf16 v[176:191], a[20:23], a[128:131], v[176:191]
    ds_read_b64_tr_b16 a[4:5], v37 offset:0
    ds_read_b64_tr_b16 a[6:7], v37 offset:512
    v_add_f32 v138, v138, v234
    v_add_f32 v139, v139, v235
    v_cvt_pk_bf16_f32 v148, v136, v137
    v_cvt_pk_bf16_f32 v149, v138, v139
    v_mfma_f32_32x32x16_bf16 v[208:223], a[20:23], a[132:135], v[208:223]
    buffer_load_dwordx4 a[216:219], v40, s[44:47], s87 offen offset:1024 sc1
    v_min_u32 v148, -2, v148
    buffer_store_dwordx2 v[148:149], v8, s[44:47], s101 offen offset:1024 sc1
    s_waitcnt lgkmcnt(4)
    v_add_f32 v140, v140, v236
    v_add_f32 v141, v141, v237
    v_mfma_f32_32x32x16_bf16 v[160:175], a[24:27], a[136:139], v[160:175]
    ds_read_b64_tr_b16 a[8:9], v36 offset:2048
    ds_read_b64_tr_b16 a[10:11], v36 offset:2560
    v_add_f32 v142, v142, v238
    v_add_f32 v143, v143, v239
    v_cvt_pk_bf16_f32 v150, v140, v141
    v_cvt_pk_bf16_f32 v151, v142, v143
    v_mfma_f32_32x32x16_bf16 v[192:207], a[24:27], a[140:143], v[192:207]
    buffer_load_dwordx4 a[220:223], v41, s[44:47], s87 offen offset:1024 sc1
    v_min_u32 v150, -2, v150
    buffer_store_dwordx2 v[150:151], v8, s[44:47], s101 offen offset:1536 sc1
    s_lshl2_add_u32 s92, s11, s88
    s_lshl_b32 s92, s92, 16
    v_mfma_f32_32x32x16_bf16 v[176:191], a[28:31], a[136:139], v[176:191]
    ds_read_b64_tr_b16 a[12:13], v37 offset:2048
    ds_read_b64_tr_b16 a[14:15], v37 offset:2560
    s_lshl_b32 s96, s10, 7
    s_add_u32 s92, s92, s96
    s_add_u32 s92, s92, 10485760
    v_lshlrev_b32 v235, 12, v124
    v_mfma_f32_32x32x16_bf16 v[208:223], a[28:31], a[140:143], v[208:223]
    v_lshl_add_u32 v235, v125, 4, v235
    v_add_u32 v236, 32768, v235
    v_and_b32 v10, 31, v1
    v_lshrrev_b32 v11, 5, v1
    v_lshlrev_b32 v11, 2, v11
    v_xor_b32 v11, v11, v125
    s_waitcnt vmcnt(21)
    v_mfma_f32_32x32x16_bf16 v[160:175], a[32:35], a[144:147], v[160:175]
    ds_read_b64_tr_b16 a[16:17], v36 offset:16384
    ds_read_b64_tr_b16 a[18:19], v36 offset:16896
    v_lshlrev_b32 v11, 4, v11
    v_lshl_add_u32 v11, v10, 8, v11
    s_lshl_b32 s95, s88, 13
    v_add_u32 v10, s95, v11
    v_mfma_f32_32x32x16_bf16 v[192:207], a[32:35], a[148:151], v[192:207]
    v_xor_b32 v11, 16, v10
    v_xor_b32 v12, 32, v10
    v_xor_b32 v13, 48, v10
    s_lshl_b32 s95, s88, 11
    v_lshlrev_b32 v32, 1, v125
    v_xor_b32 v32, v32, v124
    v_mfma_f32_32x32x16_bf16 v[176:191], a[36:39], a[144:147], v[176:191]
    ds_read_b64_tr_b16 a[20:21], v37 offset:16384
    ds_read_b64_tr_b16 a[22:23], v37 offset:16896
    v_lshlrev_b32 v32, 4, v32
    v_lshl_add_u32 v32, v124, 8, v32
    v_add_u32 v32, s95, v32
    v_xor_b32 v33, 16, v32
    v_mfma_f32_32x32x16_bf16 v[208:223], a[36:39], a[148:151], v[208:223]
    v_mfma_f32_32x32x16_bf16 v[160:175], a[40:43], a[152:155], v[160:175]
    ds_read_b64_tr_b16 a[24:25], v36 offset:18432
    ds_read_b64_tr_b16 a[26:27], v36 offset:18944
    v_mfma_f32_32x32x16_bf16 v[192:207], a[40:43], a[156:159], v[192:207]
    v_mfma_f32_32x32x16_bf16 v[176:191], a[44:47], a[152:155], v[176:191]
    ds_read_b64_tr_b16 a[28:29], v37 offset:18432
    ds_read_b64_tr_b16 a[30:31], v37 offset:18944
    v_mfma_f32_32x32x16_bf16 v[208:223], a[44:47], a[156:159], v[208:223]
    s_waitcnt vmcnt(17)
    v_mfma_f32_32x32x16_bf16 v[160:175], a[48:51], a[160:163], v[160:175]
    ds_read_b64_tr_b16 a[32:33], v34 offset:32768
    ds_read_b64_tr_b16 a[34:35], v34 offset:33280
    v_mfma_f32_32x32x16_bf16 v[192:207], a[48:51], a[164:167], v[192:207]
    v_mfma_f32_32x32x16_bf16 v[176:191], a[52:55], a[160:163], v[176:191]
    ds_read_b64_tr_b16 a[36:37], v35 offset:32768
    ds_read_b64_tr_b16 a[38:39], v35 offset:33280
    v_mfma_f32_32x32x16_bf16 v[208:223], a[52:55], a[164:167], v[208:223]
    v_mfma_f32_32x32x16_bf16 v[160:175], a[56:59], a[168:171], v[160:175]
    ds_read_b64_tr_b16 a[40:41], v34 offset:34816
    ds_read_b64_tr_b16 a[42:43], v34 offset:35328
    v_mfma_f32_32x32x16_bf16 v[192:207], a[56:59], a[172:175], v[192:207]
    v_mfma_f32_32x32x16_bf16 v[176:191], a[60:63], a[168:171], v[176:191]
    ds_read_b64_tr_b16 a[44:45], v35 offset:34816
    ds_read_b64_tr_b16 a[46:47], v35 offset:35328
    v_mfma_f32_32x32x16_bf16 v[208:223], a[60:63], a[172:175], v[208:223]
    s_waitcnt vmcnt(13)
    v_mfma_f32_32x32x16_bf16 v[160:175], a[64:67], a[176:179], v[160:175]
    ds_read_b64_tr_b16 a[48:49], v34 offset:49152
    ds_read_b64_tr_b16 a[50:51], v34 offset:49664
    v_mfma_f32_32x32x16_bf16 v[192:207], a[64:67], a[180:183], v[192:207]
    v_mfma_f32_32x32x16_bf16 v[176:191], a[68:71], a[176:179], v[176:191]
    ds_read_b64_tr_b16 a[52:53], v35 offset:49152
    ds_read_b64_tr_b16 a[54:55], v35 offset:49664
    v_mfma_f32_32x32x16_bf16 v[208:223], a[68:71], a[180:183], v[208:223]
    v_mfma_f32_32x32x16_bf16 v[160:175], a[72:75], a[184:187], v[160:175]
    ds_read_b64_tr_b16 a[56:57], v34 offset:51200
    ds_read_b64_tr_b16 a[58:59], v34 offset:51712
    v_mfma_f32_32x32x16_bf16 v[192:207], a[72:75], a[188:191], v[192:207]
    s_waitcnt vmcnt(8)
    v_cmp_gt_u32 vcc, s4, v4
    s_cbranch_vccnz L_slow2
L_back2:
    s_barrier
    buffer_load_dwordx4 v[44:47], v42, s[44:47], s81 offen offset:0 sc1
    v_mfma_f32_32x32x16_bf16 v[176:191], a[76:79], a[184:187], v[176:191]
    ds_read_b64_tr_b16 a[60:61], v35 offset:51200
    ds_read_b64_tr_b16 a[62:63], v35 offset:51712
    v_mfma_f32_32x32x16_bf16 v[208:223], a[76:79], a[188:191], v[208:223]
    buffer_load_dwordx4 v[48:51], v42, s[44:47], s81 offen offset:1024 sc1
    v_mfma_f32_32x32x16_bf16 v[160:175], a[80:83], a[192:195], v[160:175]
    ds_read_b64_tr_b16 a[64:65], v36 offset:32768
    ds_read_b64_tr_b16 a[66:67], v36 offset:33280
    v_lshlrev_b32 v14, 16, v112
    v_and_b32 v15, 0xffff0000, v112
    v_lshlrev_b32 v16, 16, v113
    v_and_b32 v17, 0xffff0000, v113
    v_mfma_f32_32x32x16_bf16 v[192:207], a[80:83], a[196:199], v[192:207]
    buffer_load_dwordx4 v[52:55], v42, s[44:47], s82 offen offset:0 sc1
    v_lshlrev_b32 v18, 16, v114
    v_and_b32 v19, 0xffff0000, v114
    v_lshlrev_b32 v20, 16, v115
    v_and_b32 v21, 0xffff0000, v115
    v_mul_f32 v120, v120, v121
    v_mfma_f32_32x32x16_bf16 v[176:191], a[84:87], a[192:195], v[176:191]
    ds_read_b64_tr_b16 a[68:69], v37 offset:32768
    ds_read_b64_tr_b16 a[70:71], v37 offset:33280
    v_fma_f32 v140, v14, v121, v120
    v_fma_f32 v141, v15, v121, v120
    v_fma_f32 v142, v16, v121, v120
    v_fma_f32 v143, v17, v121, v120
    v_mfma_f32_32x32x16_bf16 v[208:223], a[84:87], a[196:199], v[208:223]
    buffer_load_dwordx4 v[56:59], v42, s[44:47], s82 offen offset:1024 sc1
    v_fma_f32 v144, v18, v121, v120
    v_fma_f32 v145, v19, v121, v120
    v_fma_f32 v146, v20, v121, v120
    v_fma_f32 v147, v21, v121, v120
    v_lshlrev_b32 v22, 16, v116
    v_mfma_f32_32x32x16_bf16 v[160:175], a[88:91], a[200:203], v[160:175]
    ds_read_b64_tr_b16 a[72:73], v36 offset:34816
    ds_read_b64_tr_b16 a[74:75], v36 offset:35328
    v_and_b32 v23, 0xffff0000, v116
    v_lshlrev_b32 v24, 16, v117
    v_and_b32 v25, 0xffff0000, v117
    v_lshlrev_b32 v26, 16, v118
    v_mfma_f32_32x32x16_bf16 v[192:207], a[88:91], a[204:207], v[192:207]
    buffer_load_dwordx4 v[60:63], v42, s[44:47], s83 offen offset:0 sc1
    v_and_b32 v27, 0xffff0000, v118
    v_lshlrev_b32 v28, 16, v119
    v_and_b32 v29, 0xffff0000, v119
    v_mul_f32 v122, v122, v123
    v_fma_f32 v148, v22, v123, v122
    v_mfma_f32_32x32x16_bf16 v[176:191], a[92:95], a[200:203], v[176:191]
    ds_read_b64_tr_b16 a[76:77], v37 offset:34816
    ds_read_b64_tr_b16 a[78:79], v37 offset:35328
    v_fma_f32 v149, v23, v123, v122
    v_fma_f32 v150, v24, v123, v122
    v_fma_f32 v151, v25, v123, v122
    v_fma_f32 v152, v26, v123, v122
    v_mfma_f32_32x32x16_bf16 v[208:223], a[92:95], a[204:207], v[208:223]
    buffer_load_dwordx4 v[64:67], v42, s[44:47], s83 offen offset:1024 sc1
    v_fma_f32 v153, v27, v123, v122
    v_fma_f32 v154, v28, v123, v122
    v_fma_f32 v155, v29, v123, v122
    s_lshl_b32 s95, s88, 1
    v_xor_b32 v234, s95, v125
    s_waitcnt vmcnt(7)
    v_mfma_f32_32x32x16_bf16 v[160:175], a[96:99], a[208:211], v[160:175]
    ds_read_b64_tr_b16 a[80:81], v34 offset:16384
    ds_read_b64_tr_b16 a[82:83], v34 offset:16896
    v_lshlrev_b32 v234, 4, v234
    v_lshl_add_u32 v234, v124, 7, v234
    s_lshl_b32 s95, s88, 11
    s_add_u32 s95, s95, 147456
    v_mfma_f32_32x32x16_bf16 v[192:207], a[96:99], a[212:215], v[192:207]
    buffer_load_dwordx4 v[68:71], v42, s[44:47], s84 offen offset:0 sc1
    v_add_u32 v234, s95, v234
    v_xor_b32 v237, 16, v234
    v_xor_b32 v252, s88, v125
    v_lshlrev_b32 v252, 4, v252
    v_lshl_add_u32 v252, v125, 10, v252
    v_mfma_f32_32x32x16_bf16 v[176:191], a[100:103], a[208:211], v[176:191]
    ds_read_b64_tr_b16 a[84:85], v35 offset:16384
    ds_read_b64_tr_b16 a[86:87], v35 offset:16896
    v_lshl_add_u32 v252, v124, 1, v252
    v_add_u32 v252, 147456, v252
    v_xor_b32 v253, 64, v252
    v_mfma_f32_32x32x16_bf16 v[208:223], a[100:103], a[212:215], v[208:223]
    buffer_load_dwordx4 v[72:75], v42, s[44:47], s84 offen offset:1024 sc1
    v_mfma_f32_32x32x16_bf16 v[160:175], a[104:107], a[216:219], v[160:175]
    ds_read_b64_tr_b16 a[88:89], v34 offset:18432
    ds_read_b64_tr_b16 a[90:91], v34 offset:18944
    v_mfma_f32_32x32x16_bf16 v[192:207], a[104:107], a[220:223], v[192:207]
    buffer_load_dwordx4 v[76:79], v42, s[44:47], s85 offen offset:0 sc1
    v_mfma_f32_32x32x16_bf16 v[176:191], a[108:111], a[216:219], v[176:191]
    ds_read_b64_tr_b16 a[92:93], v35 offset:18432
    ds_read_b64_tr_b16 a[94:95], v35 offset:18944
    v_mfma_f32_32x32x16_bf16 v[208:223], a[108:111], a[220:223], v[208:223]
    buffer_load_dwordx4 v[80:83], v42, s[44:47], s85 offen offset:1024 sc1
    s_waitcnt vmcnt(8)
    s_waitcnt lgkmcnt(15)
    v_mfma_f32_32x32x16_bf16 v[160:175], a[0:3], v[44:47], v[160:175]
    ds_read_b64_tr_b16 a[96:97], v36 offset:49152
    ds_read_b64_tr_b16 a[98:99], v36 offset:49664
    v_mfma_f32_32x32x16_bf16 v[176:191], a[4:7], v[44:47], v[176:191]
    buffer_load_dwordx4 v[84:87], v42, s[44:47], s86 offen offset:0 sc1
    v_mfma_f32_32x32x16_bf16 v[160:175], a[8:11], v[48:51], v[160:175]
    ds_read_b64_tr_b16 a[100:101], v37 offset:49152
    ds_read_b64_tr_b16 a[102:103], v37 offset:49664
    v_mfma_f32_32x32x16_bf16 v[176:191], a[12:15], v[48:51], v[176:191]
    buffer_load_dwordx4 v[88:91], v42, s[44:47], s86 offen offset:1024 sc1
    s_waitcnt vmcnt(8)
    v_mfma_f32_32x32x16_bf16 v[160:175], a[16:19], v[52:55], v[160:175]
    ds_read_b64_tr_b16 a[104:105], v36 offset:51200
    ds_read_b64_tr_b16 a[106:107], v36 offset:51712
    v_mfma_f32_32x32x16_bf16 v[176:191], a[20:23], v[52:55], v[176:191]
    buffer_load_dwordx4 v[92:95], v42, s[44:47], s87 offen offset:0 sc1
    v_mfma_f32_32x32x16_bf16 v[160:175], a[24:27], v[56:59], v[160:175]
    ds_read_b64_tr_b16 a[108:109], v37 offset:51200
    ds_read_b64_tr_b16 a[110:111], v37 offset:51712
    v_mfma_f32_32x32x16_bf16 v[176:191], a[28:31], v[56:59], v[176:191]
    buffer_load_dwordx4 v[96:99], v42, s[44:47], s87 offen offset:1024 sc1
    s_waitcnt vmcnt(8)
    v_mfma_f32_32x32x16_bf16 v[160:175], a[32:35], v[60:63], v[160:175]
    v_mfma_f32_32x32x16_bf16 v[176:191], a[36:39], v[60:63], v[176:191]
    buffer_load_dwordx4 v[100:103], v43, s[44:47], s81 offen offset:0 sc1
    v_mfma_f32_32x32x16_bf16 v[160:175], a[40:43], v[64:67], v[160:175]
    v_mfma_f32_32x32x16_bf16 v[176:191], a[44:47], v[64:67], v[176:191]
    buffer_load_dwordx4 v[104:107], v43, s[44:47], s81 offen offset:1024 sc1
    s_waitcnt vmcnt(8)
    v_mfma_f32_32x32x16_bf16 v[160:175], a[48:51], v[68:71], v[160:175]
    v_mfma_f32_32x32x16_bf16 v[176:191], a[52:55], v[68:71], v[176:191]
    buffer_load_dwordx4 v[108:111], v43, s[44:47], s82 offen offset:0 sc1
    v_mfma_f32_32x32x16_bf16 v[160:175], a[56:59], v[72:75], v[160:175]
    v_mfma_f32_32x32x16_bf16 v[176:191], a[60:63], v[72:75], v[176:191]
    buffer_load_dwordx4 a[224:227], v43, s[44:47], s82 offen offset:1024 sc1
    s_waitcnt vmcnt(8)
    s_waitcnt lgkmcnt(15)
    v_mfma_f32_32x32x16_bf16 v[160:175], a[64:67], v[76:79], v[160:175]
    v_mfma_f32_32x32x16_bf16 v[176:191], a[68:71], v[76:79], v[176:191]
    buffer_load_dwordx4 a[228:231], v43, s[44:47], s83 offen offset:0 sc1
    v_mfma_f32_32x32x16_bf16 v[160:175], a[72:75], v[80:83], v[160:175]
    v_mfma_f32_32x32x16_bf16 v[176:191], a[76:79], v[80:83], v[176:191]
    buffer_load_dwordx4 a[232:235], v43, s[44:47], s83 offen offset:1024 sc1
    s_waitcnt vmcnt(8)
    s_waitcnt lgkmcnt(14)
    v_mfma_f32_32x32x16_bf16 v[160:175], a[80:83], v[84:87], v[160:175]
    s_waitcnt lgkmcnt(12)
    v_mfma_f32_32x32x16_bf16 v[176:191], a[84:87], v[84:87], v[176:191]
    buffer_load_dwordx4 a[236:239], v43, s[44:47], s84 offen offset:0 sc1
    s_waitcnt lgkmcnt(10)
    v_mfma_f32_32x32x16_bf16 v[160:175], a[88:91], v[88:91], v[160:175]
    s_waitcnt lgkmcnt(8)
    v_mfma_f32_32x32x16_bf16 v[176:191], a[92:95], v[88:91], v[176:191]
    buffer_load_dwordx4 a[240:243], v43, s[44:47], s84 offen offset:1024 sc1
    s_waitcnt vmcnt(8)
    s_waitcnt lgkmcnt(6)
    v_mfma_f32_32x32x16_bf16 v[160:175], a[96:99], v[92:95], v[160:175]
    s_waitcnt lgkmcnt(4)
    v_mfma_f32_32x32x16_bf16 v[176:191], a[100:103], v[92:95], v[176:191]
    buffer_load_dwordx4 v[224:227], v235, s[44:47], s92 offen sc1
    s_waitcnt lgkmcnt(2)
    v_mfma_f32_32x32x16_bf16 v[160:175], a[104:107], v[96:99], v[160:175]
    s_waitcnt lgkmcnt(0)
    v_mfma_f32_32x32x16_bf16 v[176:191], a[108:111], v[96:99], v[176:191]
    buffer_load_dwordx4 v[228:231], v236, s[44:47], s92 offen sc1
    s_barrier
    s_waitcnt vmcnt(8)
    v_mfma_f32_32x32x16_bf16 v[192:207], a[0:3], v[100:103], v[192:207]
    v_mfma_f32_32x32x16_bf16 v[208:223], a[4:7], v[100:103], v[208:223]
    buffer_load_dwordx4 a[244:247], v43, s[44:47], s85 offen offset:0 sc1
    v_mfma_f32_32x32x16_bf16 v[192:207], a[8:11], v[104:107], v[192:207]
    s_nop 2
    ds_write_b128 v10, v[160:163] offset:0
    v_mfma_f32_32x32x16_bf16 v[208:223], a[12:15], v[104:107], v[208:223]
    buffer_load_dwordx4 a[248:251], v43, s[44:47], s85 offen offset:1024 sc1
    ds_write_b128 v11, v[164:167] offset:0
    s_waitcnt vmcnt(8)
    v_mfma_f32_32x32x16_bf16 v[192:207], a[16:19], v[108:111], v[192:207]
    ds_write_b128 v12, v[168:171] offset:0
    v_mfma_f32_32x32x16_bf16 v[208:223], a[20:23], v[108:111], v[208:223]
    buffer_load_dwordx4 a[252:255], v43, s[44:47], s86 offen offset:0 sc1
    ds_write_b128 v13, v[172:175] offset:0
    v_mfma_f32_32x32x16_bf16 v[192:207], a[24:27], a[224:227], v[192:207]
    ds_write_b128 v10, v[176:179] offset:128
    v_mfma_f32_32x32x16_bf16 v[208:223], a[28:31], a[224:227], v[208:223]
    buffer_load_dwordx4 v[240:243], v43, s[44:47], s86 offen offset:1024 sc1
    ds_write_b128 v11, v[180:183] offset:128
    s_waitcnt vmcnt(8)
    v_mfma_f32_32x32x16_bf16 v[192:207], a[32:35], a[228:231], v[192:207]
    ds_write_b128 v12, v[184:187] offset:128
    v_mfma_f32_32x32x16_bf16 v[208:223], a[36:39], a[228:231], v[208:223]
    buffer_load_dwordx4 v[244:247], v43, s[44:47], s87 offen offset:0 sc1
    ds_write_b128 v13, v[188:191] offset:128
    v_mfma_f32_32x32x16_bf16 v[192:207], a[40:43], a[232:235], v[192:207]
    s_waitcnt vmcnt(5)
    v_max3_u32 v238, v224, v226, v228
    v_max_u32 v238, v238, v230
    v_cmp_eq_u32 vcc, -1, v238
    s_cbranch_vccnz L_slow4
L_back4:
    ds_write_b128 v234, v[224:227]
    ds_write_b128 v237, v[228:231] offset:1024
    v_mfma_f32_32x32x16_bf16 v[208:223], a[44:47], a[232:235], v[208:223]
    buffer_load_dwordx4 v[248:251], v43, s[44:47], s87 offen offset:1024 sc1
    v_mfma_f32_32x32x16_bf16 v[192:207], a[48:51], a[236:239], v[192:207]
    s_waitcnt lgkmcnt(0)
    s_barrier
    ds_read_b128 v[44:47], v32 offset:0
    ds_read_b128 v[48:51], v33 offset:0
    ds_read_b128 v[52:55], v32 offset:8192
    ds_read_b128 v[56:59], v33 offset:8192
    ds_read_b128 v[60:63], v32 offset:16384
    v_mfma_f32_32x32x16_bf16 v[208:223], a[52:55], a[236:239], v[208:223]
    ds_read_b128 v[64:67], v33 offset:16384
    ds_read_b128 v[68:71], v32 offset:24576
    ds_read_b128 v[72:75], v33 offset:24576
    ds_read_u16_d16_hi v128, v252 offset:0
    ds_read_u16_d16_hi v129, v252 offset:128
    ds_read_u16_d16_hi v130, v252 offset:256
    v_mfma_f32_32x32x16_bf16 v[192:207], a[56:59], a[240:243], v[192:207]
    ds_read_u16_d16_hi v131, v252 offset:384
    v_mfma_f32_32x32x16_bf16 v[208:223], a[60:63], a[240:243], v[208:223]
    s_waitcnt lgkmcnt(4)
    ds_read_u16_d16_hi v132, v252 offset:512
    v_add_f32 v44, v44, v52
    v_add_f32 v45, v45, v53
    ds_read_u16_d16_hi v133, v252 offset:640
    v_add_f32 v46, v46, v54
    v_add_f32 v47, v47, v55
    s_waitcnt vmcnt(4)
    v_mfma_f32_32x32x16_bf16 v[192:207], a[64:67], a[244:247], v[192:207]
    ds_read_u16_d16_hi v134, v252 offset:768
    v_add_f32 v48, v48, v56
    v_add_f32 v49, v49, v57
    ds_read_u16_d16_hi v135, v252 offset:896
    v_add_f32 v50, v50, v58
    v_add_f32 v51, v51, v59
    v_mfma_f32_32x32x16_bf16 v[192:207], a[72:75], a[248:251], v[192:207]
    ds_read_u16_d16_hi v136, v253 offset:0
    v_add_f32 v60, v60, v68
    v_add_f32 v61, v61, v69
    ds_read_u16_d16_hi v137, v253 offset:128
    v_add_f32 v62, v62, v70
    v_add_f32 v63, v63, v71
    s_waitcnt vmcnt(2)
    v_mfma_f32_32x32x16_bf16 v[192:207], a[80:83], a[252:255], v[192:207]
    ds_read_u16_d16_hi v138, v253 offset:256
    v_add_f32 v64, v64, v72
    v_add_f32 v65, v65, v73
    ds_read_u16_d16_hi v139, v253 offset:384
    v_add_f32 v66, v66, v74
    v_add_f32 v67, v67, v75
    v_mfma_f32_32x32x16_bf16 v[192:207], a[88:91], v[240:243], v[192:207]
    ds_read_u16_d16_hi v156, v253 offset:512
    v_add_f32 v44, v44, v60
    v_add_f32 v45, v45, v61
    ds_read_u16_d16_hi v157, v253 offset:640
    v_add_f32 v46, v46, v62
    v_add_f32 v47, v47, v63
    s_waitcnt vmcnt(0)
    v_mfma_f32_32x32x16_bf16 v[192:207], a[96:99], v[244:247], v[192:207]
    ds_read_u16_d16_hi v158, v253 offset:768
    v_add_f32 v48, v48, v64
    v_add_f32 v49, v49, v65
    ds_read_u16_d16_hi v159, v253 offset:896
    v_add_f32 v50, v50, v66
    v_add_f32 v51, v51, v67
    s_waitcnt lgkmcnt(0)
    v_mfma_f32_32x32x16_bf16 v[192:207], a[104:107], v[248:251], v[192:207]
    v_mul_f32 v140, v140, v128
    v_mul_f32 v141, v141, v129
    v_mul_f32 v142, v142, v130
    v_mul_f32 v143, v143, v131
    v_mul_f32 v144, v144, v132
    v_mul_f32 v145, v145, v133
    v_mfma_f32_32x32x16_bf16 v[208:223], a[68:71], a[244:247], v[208:223]
    v_mul_f32 v146, v146, v134
    v_mul_f32 v147, v147, v135
    v_mul_f32 v148, v148, v136
    v_mul_f32 v149, v149, v137
    v_mul_f32 v150, v150, v138
    v_mul_f32 v151, v151, v139
    v_mfma_f32_32x32x16_bf16 v[208:223], a[76:79], a[248:251], v[208:223]
    v_mul_f32 v152, v152, v156
    v_mul_f32 v153, v153, v157
    v_mul_f32 v154, v154, v158
    v_mul_f32 v155, v155, v159
    v_mul_f32 v52, 0xbfb8aa3b, v44
    v_mul_f32 v53, 0xbfb8aa3b, v45
    v_mfma_f32_32x32x16_bf16 v[208:223], a[84:87], a[252:255], v[208:223]
    ds_write_b128 v10, v[192:195] offset:32768
    v_mul_f32 v54, 0xbfb8aa3b, v46
    v_mul_f32 v55, 0xbfb8aa3b, v47
    v_mul_f32 v56, 0xbfb8aa3b, v48
    v_mul_f32 v57, 0xbfb8aa3b, v49
    v_mul_f32 v58, 0xbfb8aa3b, v50
    v_mfma_f32_32x32x16_bf16 v[208:223], a[92:95], v[240:243], v[208:223]
    ds_write_b128 v11, v[196:199] offset:32768
    v_mul_f32 v59, 0xbfb8aa3b, v51
    v_exp_f32 v52, v52
    v_exp_f32 v53, v53
    v_mfma_f32_32x32x16_bf16 v[208:223], a[100:103], v[244:247], v[208:223]
    ds_write_b128 v12, v[200:203] offset:32768
    v_exp_f32 v54, v54
    v_exp_f32 v55, v55
    v_mfma_f32_32x32x16_bf16 v[208:223], a[108:111], v[248:251], v[208:223]
    ds_write_b128 v13, v[204:207] offset:32768
    v_exp_f32 v56, v56
    v_exp_f32 v57, v57
    v_exp_f32 v58, v58
    v_exp_f32 v59, v59
    v_pk_mul_f32 v[44:45], v[44:45], v[140:141]
    v_pk_mul_f32 v[46:47], v[46:47], v[142:143]
    v_pk_mul_f32 v[48:49], v[48:49], v[144:145]
    v_pk_mul_f32 v[50:51], v[50:51], v[146:147]
    v_pk_add_f32 v[52:53], v[52:53], 1.0 op_sel_hi:[1,0]
    v_pk_add_f32 v[54:55], v[54:55], 1.0 op_sel_hi:[1,0]
    v_pk_add_f32 v[56:57], v[56:57], 1.0 op_sel_hi:[1,0]
    v_pk_add_f32 v[58:59], v[58:59], 1.0 op_sel_hi:[1,0]
    v_rcp_f32 v52, v52
    ds_write_b128 v10, v[208:211] offset:32896
    v_rcp_f32 v53, v53
    v_rcp_f32 v54, v54
    v_rcp_f32 v55, v55
    ds_write_b128 v11, v[212:215] offset:32896
    v_rcp_f32 v56, v56
    v_rcp_f32 v57, v57
    v_rcp_f32 v58, v58
    ds_write_b128 v12, v[216:219] offset:32896
    v_rcp_f32 v59, v59
    v_pk_fma_f32 v[44:45], v[44:45], v[52:53], v[14:15]
    v_pk_fma_f32 v[46:47], v[46:47], v[54:55], v[16:17]
    v_pk_fma_f32 v[48:49], v[48:49], v[56:57], v[18:19]
    v_pk_fma_f32 v[50:51], v[50:51], v[58:59], v[20:21]
    ds_write_b128 v13, v[220:223] offset:32896
    v_cvt_pk_bf16_f32 v60, v44, v45
    v_cvt_pk_bf16_f32 v61, v46, v47
    v_cvt_pk_bf16_f32 v62, v48, v49
    v_cvt_pk_bf16_f32 v63, v50, v51
    buffer_store_dwordx4 v[60:63], v30, s[52:55], 0 offen
    s_waitcnt lgkmcnt(0)
    s_barrier
    ds_read_b128 v[76:79], v32 offset:32768
    ds_read_b128 v[80:83], v33 offset:32768
    ds_read_b128 v[84:87], v32 offset:40960
    ds_read_b128 v[88:91], v33 offset:40960
    ds_read_b128 v[92:95], v32 offset:49152
    ds_read_b128 v[96:99], v33 offset:49152
    ds_read_b128 v[100:103], v32 offset:57344
    ds_read_b128 v[104:107], v33 offset:57344
    s_waitcnt lgkmcnt(4)
    v_pk_add_f32 v[76:77], v[76:77], v[84:85]
    v_pk_add_f32 v[78:79], v[78:79], v[86:87]
    v_pk_add_f32 v[80:81], v[80:81], v[88:89]
    v_pk_add_f32 v[82:83], v[82:83], v[90:91]
    s_waitcnt lgkmcnt(1)
    v_pk_add_f32 v[92:93], v[92:93], v[100:101]
    v_pk_add_f32 v[94:95], v[94:95], v[102:103]
    s_waitcnt lgkmcnt(0)
    v_pk_add_f32 v[96:97], v[96:97], v[104:105]
    v_pk_add_f32 v[98:99], v[98:99], v[106:107]
    v_pk_add_f32 v[76:77], v[76:77], v[92:93]
    v_pk_add_f32 v[78:79], v[78:79], v[94:95]
    v_pk_add_f32 v[80:81], v[80:81], v[96:97]
    v_pk_add_f32 v[82:83], v[82:83], v[98:99]
    v_mul_f32 v84, 0xbfb8aa3b, v76
    v_mul_f32 v85, 0xbfb8aa3b, v77
    v_mul_f32 v86, 0xbfb8aa3b, v78
    v_mul_f32 v87, 0xbfb8aa3b, v79
    v_mul_f32 v88, 0xbfb8aa3b, v80
    v_mul_f32 v89, 0xbfb8aa3b, v81
    v_mul_f32 v90, 0xbfb8aa3b, v82
    v_mul_f32 v91, 0xbfb8aa3b, v83
    v_exp_f32 v84, v84
    v_exp_f32 v85, v85
    v_exp_f32 v86, v86
    v_exp_f32 v87, v87
    v_exp_f32 v88, v88
    v_exp_f32 v89, v89
    v_exp_f32 v90, v90
    v_exp_f32 v91, v91
    v_pk_mul_f32 v[76:77], v[76:77], v[148:149]
    v_pk_mul_f32 v[78:79], v[78:79], v[150:151]
    v_pk_mul_f32 v[80:81], v[80:81], v[152:153]
    v_pk_mul_f32 v[82:83], v[82:83], v[154:155]
    v_pk_add_f32 v[84:85], v[84:85], 1.0 op_sel_hi:[1,0]
    v_pk_add_f32 v[86:87], v[86:87], 1.0 op_sel_hi:[1,0]
    v_pk_add_f32 v[88:89], v[88:89], 1.0 op_sel_hi:[1,0]
    v_pk_add_f32 v[90:91], v[90:91], 1.0 op_sel_hi:[1,0]
    v_rcp_f32 v84, v84
    v_rcp_f32 v85, v85
    v_rcp_f32 v86, v86
    v_rcp_f32 v87, v87
    v_rcp_f32 v88, v88
    v_rcp_f32 v89, v89
    v_rcp_f32 v90, v90
    v_rcp_f32 v91, v91
    v_pk_fma_f32 v[76:77], v[76:77], v[84:85], v[22:23]
    v_pk_fma_f32 v[78:79], v[78:79], v[86:87], v[24:25]
    v_pk_fma_f32 v[80:81], v[80:81], v[88:89], v[26:27]
    v_pk_fma_f32 v[82:83], v[82:83], v[90:91], v[28:29]
    v_cvt_pk_bf16_f32 v92, v76, v77
    v_cvt_pk_bf16_f32 v93, v78, v79
    v_cvt_pk_bf16_f32 v94, v80, v81
    v_cvt_pk_bf16_f32 v95, v82, v83
    buffer_store_dwordx4 v[92:95], v31, s[52:55], 0 offen
    s_endpgm
L_helper:
    s_waitcnt lgkmcnt(0)
    s_getpc_b64 s[66:67]
L_hpc:
    s_sub_u32 s66, s66, L_hpc-recurrent_scan__ssm_conv_h3__glu_gated_geglu__prompt_kernel
    s_subb_u32 s67, s67, 0
    s_sub_u32 s68, s2, 224
    s_lshr_b32 s68, s68, 3
    s_lshl2_add_u32 s68, s68, s88
    s_lshl_b32 s68, s68, 11
    v_and_b32 v2, 15, v1
    v_lshlrev_b32 v2, 7, v2
    v_add_u32 v2, s68, v2
    v_min_u32 v2, L_exit-recurrent_scan__ssm_conv_h3__glu_gated_geglu__prompt_kernel, v2
    global_load_dword a0, v2, s[66:67]
    s_mov_b32 s32, s6
    s_mov_b32 s33, s7
    s_mov_b32 s34, 1835008
    s_mov_b32 s35, 0x20000
    s_mov_b32 s36, s8
    s_mov_b32 s37, s9
    s_mov_b32 s38, 1835008
    s_mov_b32 s39, 0x20000
    s_mov_b32 s40, s10
    s_mov_b32 s41, s11
    s_mov_b32 s42, 3584
    s_mov_b32 s43, 0x20000
    s_mov_b32 s44, s28
    s_mov_b32 s45, s29
    s_mov_b32 s46, 15728640
    s_mov_b32 s47, 0x20000
    s_mov_b32 s56, s26
    s_mov_b32 s57, s27
    s_mov_b32 s58, 256
    s_mov_b32 s59, 0x20000
    s_sub_u32 s60, s2, 224
    s_or_b32 s95, s60, s88
    s_cmp_eq_u32 s95, 0
    s_cselect_b32 s98, 0, 2130706432
    s_add_u32 s95, s98, 7405568
    v_lshl_add_u32 v2, v1, 4, s95
    v_add_u32 v3, 4096, v2
    v_mov_b32 v4, 0
    v_mov_b32 v5, 0
    v_mov_b32 v6, 0
    v_mov_b32 v7, 0
    buffer_store_dwordx4 v[4:7], v2, s[44:47], 0 offen offset:0 sc1
    buffer_store_dwordx4 v[4:7], v2, s[44:47], 0 offen offset:1024 sc1
    buffer_store_dwordx4 v[4:7], v2, s[44:47], 0 offen offset:2048 sc1
    buffer_store_dwordx4 v[4:7], v2, s[44:47], 0 offen offset:3072 sc1
    buffer_store_dwordx4 v[4:7], v3, s[44:47], 0 offen offset:0 sc1
    buffer_store_dwordx4 v[4:7], v3, s[44:47], 0 offen offset:1024 sc1
    buffer_store_dwordx4 v[4:7], v3, s[44:47], 0 offen offset:2048 sc1
    buffer_store_dwordx4 v[4:7], v3, s[44:47], 0 offen offset:3072 sc1
    s_lshl_b32 s95, s60, 6
    s_lshl_b32 s96, s88, 4
    s_add_u32 s95, s95, s96
    s_mul_i32 s95, s95, 896
    v_lshl_add_u32 v8, v1, 4, s95
    v_add_u32 v9, 3584, v8
    v_add_u32 v10, 7168, v8
    v_add_u32 v11, 10752, v8
    v_subrev_u32 v12, 2688, v8
    v_subrev_u32 v13, 1792, v8
    v_subrev_u32 v14, 896, v8
    v_lshlrev_b32 v15, 4, v0
    s_lshl_b32 s95, s88, 10
    s_add_u32 m0, s95, 65536
    s_nop 0
    buffer_load_dwordx4 v15, s[40:43], 0 offen lds
    buffer_load_dwordx4 v[32:35], v12, s[32:35], 0 offen
    buffer_load_dwordx4 v[36:39], v13, s[32:35], 0 offen
    buffer_load_dwordx4 v[40:43], v14, s[32:35], 0 offen
    buffer_load_dwordx4 v[44:47], v8, s[32:35], 0 offen offset:0
    buffer_load_dwordx4 v[108:111], v8, s[36:39], 0 offen offset:0
    buffer_load_dwordx4 v[48:51], v8, s[32:35], 0 offen offset:896
    buffer_load_dwordx4 v[112:115], v8, s[36:39], 0 offen offset:896
    v_lshlrev_b32 v15, 6, v1
    v_add_u32 v15, 65536, v15
    s_waitcnt vmcnt(7)
    s_barrier
    ds_read_b128 v[16:19], v15 offset:0
    ds_read_b128 v[20:23], v15 offset:16
    ds_read_b128 v[24:27], v15 offset:32
    ds_read_b128 v[28:31], v15 offset:48
    v_mov_b32 v2, 2130706432
    v_writelane_b32 v2, s98, 0
    v_mov_b32 v7, 2
    buffer_store_dword v7, v2, s[56:59], 0 offen sc1
    s_mov_b32 s61, 0xffff0000
    s_sub_u32 s95, 3, s88
    s_lshl_b32 s95, s95, 1
    v_and_b32 v4, 7, v1
    v_xor_b32 v5, s95, v4
    v_lshlrev_b32 v5, 4, v5
    v_lshl_add_u32 v5, v1, 10, v5
    v_xor_b32 v6, 16, v5
    s_mov_b32 s64, 0x05040100
    s_mov_b32 s65, 0x07060302
    s_waitcnt vmcnt(6)
    v_perm_b32 v204, v32, v36, s64
    v_perm_b32 v205, v32, v36, s65
    v_perm_b32 v206, v33, v37, s64
    v_perm_b32 v207, v33, v37, s65
    v_perm_b32 v208, v34, v38, s64
    v_perm_b32 v209, v34, v38, s65
    v_perm_b32 v210, v35, v39, s64
    v_perm_b32 v211, v35, v39, s65
    s_waitcnt lgkmcnt(3)
    v_dot2_f32_bf16 v220, v204, v17, 0
    v_dot2_f32_bf16 v221, v205, v19, 0
    s_waitcnt lgkmcnt(2)
    v_dot2_f32_bf16 v222, v206, v21, 0
    v_dot2_f32_bf16 v223, v207, v23, 0
    s_waitcnt lgkmcnt(1)
    v_dot2_f32_bf16 v224, v208, v25, 0
    v_dot2_f32_bf16 v225, v209, v27, 0
    s_waitcnt lgkmcnt(0)
    v_dot2_f32_bf16 v226, v210, v29, 0
    v_dot2_f32_bf16 v227, v211, v31, 0
    buffer_load_dwordx4 v[52:55], v8, s[32:35], 0 offen offset:1792
    buffer_load_dwordx4 v[116:119], v8, s[36:39], 0 offen offset:1792
    buffer_load_dwordx4 v[56:59], v8, s[32:35], 0 offen offset:2688
    buffer_load_dwordx4 v[120:123], v8, s[36:39], 0 offen offset:2688
    s_waitcnt vmcnt(9)
    v_perm_b32 v204, v36, v40, s64
    v_perm_b32 v205, v36, v40, s65
    v_perm_b32 v206, v37, v41, s64
    v_perm_b32 v207, v37, v41, s65
    v_perm_b32 v208, v38, v42, s64
    v_perm_b32 v209, v38, v42, s65
    v_perm_b32 v210, v39, v43, s64
    v_perm_b32 v211, v39, v43, s65
    v_dot2_f32_bf16 v212, v204, v17, 0
    v_dot2_f32_bf16 v213, v205, v19, 0
    v_dot2_f32_bf16 v214, v206, v21, 0
    v_dot2_f32_bf16 v215, v207, v23, 0
    v_dot2_f32_bf16 v216, v208, v25, 0
    v_dot2_f32_bf16 v217, v209, v27, 0
    v_dot2_f32_bf16 v218, v210, v29, 0
    v_dot2_f32_bf16 v219, v211, v31, 0
    buffer_load_dwordx4 v[60:63], v9, s[32:35], 0 offen offset:0
    buffer_load_dwordx4 v[124:127], v9, s[36:39], 0 offen offset:0
    buffer_load_dwordx4 v[64:67], v9, s[32:35], 0 offen offset:896
    buffer_load_dwordx4 v[128:131], v9, s[36:39], 0 offen offset:896
    s_waitcnt vmcnt(12)
    v_perm_b32 v204, v40, v44, s64
    v_perm_b32 v205, v40, v44, s65
    v_perm_b32 v206, v41, v45, s64
    v_perm_b32 v207, v41, v45, s65
    v_perm_b32 v208, v42, v46, s64
    v_perm_b32 v209, v42, v46, s65
    v_perm_b32 v210, v43, v47, s64
    v_perm_b32 v211, v43, v47, s65
    buffer_load_dwordx4 v[68:71], v9, s[32:35], 0 offen offset:1792
    buffer_load_dwordx4 v[132:135], v9, s[36:39], 0 offen offset:1792
    v_dot2_f32_bf16 v240, v204, v16, v220
    v_dot2_f32_bf16 v241, v205, v18, v221
    v_dot2_f32_bf16 v242, v206, v20, v222
    v_dot2_f32_bf16 v243, v207, v22, v223
    v_dot2_f32_bf16 v244, v208, v24, v224
    v_dot2_f32_bf16 v245, v209, v26, v225
    v_dot2_f32_bf16 v246, v210, v28, v226
    v_dot2_f32_bf16 v247, v211, v30, v227
    v_dot2_f32_bf16 v220, v204, v17, 0
    v_dot2_f32_bf16 v221, v205, v19, 0
    v_dot2_f32_bf16 v222, v206, v21, 0
    v_dot2_f32_bf16 v223, v207, v23, 0
    v_dot2_f32_bf16 v224, v208, v25, 0
    v_dot2_f32_bf16 v225, v209, v27, 0
    v_dot2_f32_bf16 v226, v210, v29, 0
    v_dot2_f32_bf16 v227, v211, v31, 0
    buffer_load_dwordx4 v[72:75], v9, s[32:35], 0 offen offset:2688
    s_waitcnt vmcnt(14)
    v_lshlrev_b32 v236, 16, v108
    v_and_b32 v237, s61, v108
    v_pk_mul_f32 v[240:241], v[240:241], v[236:237]
    v_lshlrev_b32 v238, 16, v109
    v_and_b32 v239, s61, v109
    v_pk_mul_f32 v[242:243], v[242:243], v[238:239]
    v_lshlrev_b32 v236, 16, v110
    v_and_b32 v237, s61, v110
    v_pk_mul_f32 v[244:245], v[244:245], v[236:237]
    v_lshlrev_b32 v238, 16, v111
    v_and_b32 v239, s61, v111
    v_pk_mul_f32 v[246:247], v[246:247], v[238:239]
    s_waitcnt vmcnt(13)
    v_perm_b32 v204, v44, v48, s64
    v_perm_b32 v205, v44, v48, s65
    v_perm_b32 v206, v45, v49, s64
    v_perm_b32 v207, v45, v49, s65
    v_perm_b32 v208, v46, v50, s64
    v_perm_b32 v209, v46, v50, s65
    v_perm_b32 v210, v47, v51, s64
    v_perm_b32 v211, v47, v51, s65
    buffer_load_dwordx4 v[136:139], v9, s[36:39], 0 offen offset:2688
    buffer_load_dwordx4 v[76:79], v10, s[32:35], 0 offen offset:0
    v_dot2_f32_bf16 v248, v204, v16, v212
    v_dot2_f32_bf16 v249, v205, v18, v213
    v_dot2_f32_bf16 v250, v206, v20, v214
    v_dot2_f32_bf16 v251, v207, v22, v215
    v_dot2_f32_bf16 v252, v208, v24, v216
    v_dot2_f32_bf16 v253, v209, v26, v217
    v_dot2_f32_bf16 v254, v210, v28, v218
    v_dot2_f32_bf16 v255, v211, v30, v219
    v_dot2_f32_bf16 v212, v204, v17, 0
    v_dot2_f32_bf16 v213, v205, v19, 0
    v_dot2_f32_bf16 v214, v206, v21, 0
    v_dot2_f32_bf16 v215, v207, v23, 0
    v_dot2_f32_bf16 v216, v208, v25, 0
    v_dot2_f32_bf16 v217, v209, v27, 0
    v_dot2_f32_bf16 v218, v210, v29, 0
    v_dot2_f32_bf16 v219, v211, v31, 0
    buffer_load_dwordx4 v[140:143], v10, s[36:39], 0 offen offset:0
    s_waitcnt vmcnt(15)
    v_lshlrev_b32 v236, 16, v112
    v_and_b32 v237, s61, v112
    v_pk_mul_f32 v[248:249], v[248:249], v[236:237]
    v_lshlrev_b32 v238, 16, v113
    v_and_b32 v239, s61, v113
    v_pk_mul_f32 v[250:251], v[250:251], v[238:239]
    v_lshlrev_b32 v236, 16, v114
    v_and_b32 v237, s61, v114
    v_pk_mul_f32 v[252:253], v[252:253], v[236:237]
    v_lshlrev_b32 v238, 16, v115
    v_and_b32 v239, s61, v115
    v_pk_mul_f32 v[254:255], v[254:255], v[238:239]
    v_cvt_pk_bf16_f32 v175, v248, v240
    v_cvt_pk_bf16_f32 v179, v249, v241
    v_cvt_pk_bf16_f32 v183, v250, v242
    v_cvt_pk_bf16_f32 v187, v251, v243
    v_cvt_pk_bf16_f32 v191, v252, v244
    v_cvt_pk_bf16_f32 v195, v253, v245
    v_cvt_pk_bf16_f32 v199, v254, v246
    v_cvt_pk_bf16_f32 v203, v255, v247
    s_waitcnt vmcnt(13)
    v_perm_b32 v204, v48, v52, s64
    v_perm_b32 v205, v48, v52, s65
    v_perm_b32 v206, v49, v53, s64
    v_perm_b32 v207, v49, v53, s65
    v_perm_b32 v208, v50, v54, s64
    v_perm_b32 v209, v50, v54, s65
    v_perm_b32 v210, v51, v55, s64
    v_perm_b32 v211, v51, v55, s65
    buffer_load_dwordx4 v[80:83], v10, s[32:35], 0 offen offset:896
    v_dot2_f32_bf16 v240, v204, v16, v220
    v_dot2_f32_bf16 v241, v205, v18, v221
    v_dot2_f32_bf16 v242, v206, v20, v222
    v_dot2_f32_bf16 v243, v207, v22, v223
    v_dot2_f32_bf16 v244, v208, v24, v224
    v_dot2_f32_bf16 v245, v209, v26, v225
    v_dot2_f32_bf16 v246, v210, v28, v226
    v_dot2_f32_bf16 v247, v211, v30, v227
    v_dot2_f32_bf16 v220, v204, v17, 0
    v_dot2_f32_bf16 v221, v205, v19, 0
    v_dot2_f32_bf16 v222, v206, v21, 0
    v_dot2_f32_bf16 v223, v207, v23, 0
    v_dot2_f32_bf16 v224, v208, v25, 0
    v_dot2_f32_bf16 v225, v209, v27, 0
    v_dot2_f32_bf16 v226, v210, v29, 0
    v_dot2_f32_bf16 v227, v211, v31, 0
    buffer_load_dwordx4 v[144:147], v10, s[36:39], 0 offen offset:896
    s_waitcnt vmcnt(14)
    v_lshlrev_b32 v236, 16, v116
    v_and_b32 v237, s61, v116
    v_pk_mul_f32 v[240:241], v[240:241], v[236:237]
    v_lshlrev_b32 v238, 16, v117
    v_and_b32 v239, s61, v117
    v_pk_mul_f32 v[242:243], v[242:243], v[238:239]
    v_lshlrev_b32 v236, 16, v118
    v_and_b32 v237, s61, v118
    v_pk_mul_f32 v[244:245], v[244:245], v[236:237]
    v_lshlrev_b32 v238, 16, v119
    v_and_b32 v239, s61, v119
    v_pk_mul_f32 v[246:247], v[246:247], v[238:239]
    s_waitcnt vmcnt(13)
    v_perm_b32 v204, v52, v56, s64
    v_perm_b32 v205, v52, v56, s65
    v_perm_b32 v206, v53, v57, s64
    v_perm_b32 v207, v53, v57, s65
    v_perm_b32 v208, v54, v58, s64
    v_perm_b32 v209, v54, v58, s65
    v_perm_b32 v210, v55, v59, s64
    v_perm_b32 v211, v55, v59, s65
    buffer_load_dwordx4 v[84:87], v10, s[32:35], 0 offen offset:1792
    v_dot2_f32_bf16 v248, v204, v16, v212
    v_dot2_f32_bf16 v249, v205, v18, v213
    v_dot2_f32_bf16 v250, v206, v20, v214
    v_dot2_f32_bf16 v251, v207, v22, v215
    v_dot2_f32_bf16 v252, v208, v24, v216
    v_dot2_f32_bf16 v253, v209, v26, v217
    v_dot2_f32_bf16 v254, v210, v28, v218
    v_dot2_f32_bf16 v255, v211, v30, v219
    v_dot2_f32_bf16 v212, v204, v17, 0
    v_dot2_f32_bf16 v213, v205, v19, 0
    v_dot2_f32_bf16 v214, v206, v21, 0
    v_dot2_f32_bf16 v215, v207, v23, 0
    v_dot2_f32_bf16 v216, v208, v25, 0
    v_dot2_f32_bf16 v217, v209, v27, 0
    v_dot2_f32_bf16 v218, v210, v29, 0
    v_dot2_f32_bf16 v219, v211, v31, 0
    buffer_load_dwordx4 v[148:151], v10, s[36:39], 0 offen offset:1792
    s_waitcnt vmcnt(14)
    v_lshlrev_b32 v236, 16, v120
    v_and_b32 v237, s61, v120
    v_pk_mul_f32 v[248:249], v[248:249], v[236:237]
    v_lshlrev_b32 v238, 16, v121
    v_and_b32 v239, s61, v121
    v_pk_mul_f32 v[250:251], v[250:251], v[238:239]
    v_lshlrev_b32 v236, 16, v122
    v_and_b32 v237, s61, v122
    v_pk_mul_f32 v[252:253], v[252:253], v[236:237]
    v_lshlrev_b32 v238, 16, v123
    v_and_b32 v239, s61, v123
    v_pk_mul_f32 v[254:255], v[254:255], v[238:239]
    v_cvt_pk_bf16_f32 v174, v248, v240
    v_cvt_pk_bf16_f32 v178, v249, v241
    v_cvt_pk_bf16_f32 v182, v250, v242
    v_cvt_pk_bf16_f32 v186, v251, v243
    v_cvt_pk_bf16_f32 v190, v252, v244
    v_cvt_pk_bf16_f32 v194, v253, v245
    v_cvt_pk_bf16_f32 v198, v254, v246
    v_cvt_pk_bf16_f32 v202, v255, v247
    s_waitcnt vmcnt(13)
    v_perm_b32 v204, v56, v60, s64
    v_perm_b32 v205, v56, v60, s65
    v_perm_b32 v206, v57, v61, s64
    v_perm_b32 v207, v57, v61, s65
    v_perm_b32 v208, v58, v62, s64
    v_perm_b32 v209, v58, v62, s65
    v_perm_b32 v210, v59, v63, s64
    v_perm_b32 v211, v59, v63, s65
    buffer_load_dwordx4 v[88:91], v10, s[32:35], 0 offen offset:2688
    v_dot2_f32_bf16 v240, v204, v16, v220
    v_dot2_f32_bf16 v241, v205, v18, v221
    v_dot2_f32_bf16 v242, v206, v20, v222
    v_dot2_f32_bf16 v243, v207, v22, v223
    v_dot2_f32_bf16 v244, v208, v24, v224
    v_dot2_f32_bf16 v245, v209, v26, v225
    v_dot2_f32_bf16 v246, v210, v28, v226
    v_dot2_f32_bf16 v247, v211, v30, v227
    v_dot2_f32_bf16 v220, v204, v17, 0
    v_dot2_f32_bf16 v221, v205, v19, 0
    v_dot2_f32_bf16 v222, v206, v21, 0
    v_dot2_f32_bf16 v223, v207, v23, 0
    v_dot2_f32_bf16 v224, v208, v25, 0
    v_dot2_f32_bf16 v225, v209, v27, 0
    v_dot2_f32_bf16 v226, v210, v29, 0
    v_dot2_f32_bf16 v227, v211, v31, 0
    buffer_load_dwordx4 v[152:155], v10, s[36:39], 0 offen offset:2688
    s_waitcnt vmcnt(14)
    v_lshlrev_b32 v236, 16, v124
    v_and_b32 v237, s61, v124
    v_pk_mul_f32 v[240:241], v[240:241], v[236:237]
    v_lshlrev_b32 v238, 16, v125
    v_and_b32 v239, s61, v125
    v_pk_mul_f32 v[242:243], v[242:243], v[238:239]
    v_lshlrev_b32 v236, 16, v126
    v_and_b32 v237, s61, v126
    v_pk_mul_f32 v[244:245], v[244:245], v[236:237]
    v_lshlrev_b32 v238, 16, v127
    v_and_b32 v239, s61, v127
    v_pk_mul_f32 v[246:247], v[246:247], v[238:239]
    s_waitcnt vmcnt(13)
    v_perm_b32 v204, v60, v64, s64
    v_perm_b32 v205, v60, v64, s65
    v_perm_b32 v206, v61, v65, s64
    v_perm_b32 v207, v61, v65, s65
    v_perm_b32 v208, v62, v66, s64
    v_perm_b32 v209, v62, v66, s65
    v_perm_b32 v210, v63, v67, s64
    v_perm_b32 v211, v63, v67, s65
    buffer_load_dwordx4 v[92:95], v11, s[32:35], 0 offen offset:0
    v_dot2_f32_bf16 v248, v204, v16, v212
    v_dot2_f32_bf16 v249, v205, v18, v213
    v_dot2_f32_bf16 v250, v206, v20, v214
    v_dot2_f32_bf16 v251, v207, v22, v215
    v_dot2_f32_bf16 v252, v208, v24, v216
    v_dot2_f32_bf16 v253, v209, v26, v217
    v_dot2_f32_bf16 v254, v210, v28, v218
    v_dot2_f32_bf16 v255, v211, v30, v219
    v_dot2_f32_bf16 v212, v204, v17, 0
    v_dot2_f32_bf16 v213, v205, v19, 0
    v_dot2_f32_bf16 v214, v206, v21, 0
    v_dot2_f32_bf16 v215, v207, v23, 0
    v_dot2_f32_bf16 v216, v208, v25, 0
    v_dot2_f32_bf16 v217, v209, v27, 0
    v_dot2_f32_bf16 v218, v210, v29, 0
    v_dot2_f32_bf16 v219, v211, v31, 0
    buffer_load_dwordx4 v[156:159], v11, s[36:39], 0 offen offset:0
    s_waitcnt vmcnt(14)
    v_lshlrev_b32 v236, 16, v128
    v_and_b32 v237, s61, v128
    v_pk_mul_f32 v[248:249], v[248:249], v[236:237]
    v_lshlrev_b32 v238, 16, v129
    v_and_b32 v239, s61, v129
    v_pk_mul_f32 v[250:251], v[250:251], v[238:239]
    v_lshlrev_b32 v236, 16, v130
    v_and_b32 v237, s61, v130
    v_pk_mul_f32 v[252:253], v[252:253], v[236:237]
    v_lshlrev_b32 v238, 16, v131
    v_and_b32 v239, s61, v131
    v_pk_mul_f32 v[254:255], v[254:255], v[238:239]
    v_cvt_pk_bf16_f32 v173, v248, v240
    v_cvt_pk_bf16_f32 v177, v249, v241
    v_cvt_pk_bf16_f32 v181, v250, v242
    v_cvt_pk_bf16_f32 v185, v251, v243
    v_cvt_pk_bf16_f32 v189, v252, v244
    v_cvt_pk_bf16_f32 v193, v253, v245
    v_cvt_pk_bf16_f32 v197, v254, v246
    v_cvt_pk_bf16_f32 v201, v255, v247
    s_waitcnt vmcnt(13)
    v_perm_b32 v204, v64, v68, s64
    v_perm_b32 v205, v64, v68, s65
    v_perm_b32 v206, v65, v69, s64
    v_perm_b32 v207, v65, v69, s65
    v_perm_b32 v208, v66, v70, s64
    v_perm_b32 v209, v66, v70, s65
    v_perm_b32 v210, v67, v71, s64
    v_perm_b32 v211, v67, v71, s65
    buffer_load_dwordx4 v[96:99], v11, s[32:35], 0 offen offset:896
    v_dot2_f32_bf16 v240, v204, v16, v220
    v_dot2_f32_bf16 v241, v205, v18, v221
    v_dot2_f32_bf16 v242, v206, v20, v222
    v_dot2_f32_bf16 v243, v207, v22, v223
    v_dot2_f32_bf16 v244, v208, v24, v224
    v_dot2_f32_bf16 v245, v209, v26, v225
    v_dot2_f32_bf16 v246, v210, v28, v226
    v_dot2_f32_bf16 v247, v211, v30, v227
    v_dot2_f32_bf16 v220, v204, v17, 0
    v_dot2_f32_bf16 v221, v205, v19, 0
    v_dot2_f32_bf16 v222, v206, v21, 0
    v_dot2_f32_bf16 v223, v207, v23, 0
    v_dot2_f32_bf16 v224, v208, v25, 0
    v_dot2_f32_bf16 v225, v209, v27, 0
    v_dot2_f32_bf16 v226, v210, v29, 0
    v_dot2_f32_bf16 v227, v211, v31, 0
    buffer_load_dwordx4 v[160:163], v11, s[36:39], 0 offen offset:896
    s_waitcnt vmcnt(14)
    v_lshlrev_b32 v236, 16, v132
    v_and_b32 v237, s61, v132
    v_pk_mul_f32 v[240:241], v[240:241], v[236:237]
    v_lshlrev_b32 v238, 16, v133
    v_and_b32 v239, s61, v133
    v_pk_mul_f32 v[242:243], v[242:243], v[238:239]
    v_lshlrev_b32 v236, 16, v134
    v_and_b32 v237, s61, v134
    v_pk_mul_f32 v[244:245], v[244:245], v[236:237]
    v_lshlrev_b32 v238, 16, v135
    v_and_b32 v239, s61, v135
    v_pk_mul_f32 v[246:247], v[246:247], v[238:239]
    s_waitcnt vmcnt(13)
    v_perm_b32 v204, v68, v72, s64
    v_perm_b32 v205, v68, v72, s65
    v_perm_b32 v206, v69, v73, s64
    v_perm_b32 v207, v69, v73, s65
    v_perm_b32 v208, v70, v74, s64
    v_perm_b32 v209, v70, v74, s65
    v_perm_b32 v210, v71, v75, s64
    v_perm_b32 v211, v71, v75, s65
    buffer_load_dwordx4 v[100:103], v11, s[32:35], 0 offen offset:1792
    v_dot2_f32_bf16 v248, v204, v16, v212
    v_dot2_f32_bf16 v249, v205, v18, v213
    v_dot2_f32_bf16 v250, v206, v20, v214
    v_dot2_f32_bf16 v251, v207, v22, v215
    v_dot2_f32_bf16 v252, v208, v24, v216
    v_dot2_f32_bf16 v253, v209, v26, v217
    v_dot2_f32_bf16 v254, v210, v28, v218
    v_dot2_f32_bf16 v255, v211, v30, v219
    v_dot2_f32_bf16 v212, v204, v17, 0
    v_dot2_f32_bf16 v213, v205, v19, 0
    v_dot2_f32_bf16 v214, v206, v21, 0
    v_dot2_f32_bf16 v215, v207, v23, 0
    v_dot2_f32_bf16 v216, v208, v25, 0
    v_dot2_f32_bf16 v217, v209, v27, 0
    v_dot2_f32_bf16 v218, v210, v29, 0
    v_dot2_f32_bf16 v219, v211, v31, 0
    buffer_load_dwordx4 v[164:167], v11, s[36:39], 0 offen offset:1792
    s_waitcnt vmcnt(14)
    v_lshlrev_b32 v236, 16, v136
    v_and_b32 v237, s61, v136
    v_pk_mul_f32 v[248:249], v[248:249], v[236:237]
    v_lshlrev_b32 v238, 16, v137
    v_and_b32 v239, s61, v137
    v_pk_mul_f32 v[250:251], v[250:251], v[238:239]
    v_lshlrev_b32 v236, 16, v138
    v_and_b32 v237, s61, v138
    v_pk_mul_f32 v[252:253], v[252:253], v[236:237]
    v_lshlrev_b32 v238, 16, v139
    v_and_b32 v239, s61, v139
    v_pk_mul_f32 v[254:255], v[254:255], v[238:239]
    v_cvt_pk_bf16_f32 v172, v248, v240
    v_cvt_pk_bf16_f32 v176, v249, v241
    v_cvt_pk_bf16_f32 v180, v250, v242
    v_cvt_pk_bf16_f32 v184, v251, v243
    v_cvt_pk_bf16_f32 v188, v252, v244
    v_cvt_pk_bf16_f32 v192, v253, v245
    v_cvt_pk_bf16_f32 v196, v254, v246
    v_cvt_pk_bf16_f32 v200, v255, v247
    ds_write_b128 v6, v[172:175] offset:0
    ds_write_b128 v6, v[176:179] offset:128
    ds_write_b128 v6, v[180:183] offset:256
    ds_write_b128 v6, v[184:187] offset:384
    ds_write_b128 v6, v[188:191] offset:512
    ds_write_b128 v6, v[192:195] offset:640
    ds_write_b128 v6, v[196:199] offset:768
    ds_write_b128 v6, v[200:203] offset:896
    s_waitcnt vmcnt(13)
    v_perm_b32 v204, v72, v76, s64
    v_perm_b32 v205, v72, v76, s65
    v_perm_b32 v206, v73, v77, s64
    v_perm_b32 v207, v73, v77, s65
    v_perm_b32 v208, v74, v78, s64
    v_perm_b32 v209, v74, v78, s65
    v_perm_b32 v210, v75, v79, s64
    v_perm_b32 v211, v75, v79, s65
    buffer_load_dwordx4 v[104:107], v11, s[32:35], 0 offen offset:2688
    v_dot2_f32_bf16 v240, v204, v16, v220
    v_dot2_f32_bf16 v241, v205, v18, v221
    v_dot2_f32_bf16 v242, v206, v20, v222
    v_dot2_f32_bf16 v243, v207, v22, v223
    v_dot2_f32_bf16 v244, v208, v24, v224
    v_dot2_f32_bf16 v245, v209, v26, v225
    v_dot2_f32_bf16 v246, v210, v28, v226
    v_dot2_f32_bf16 v247, v211, v30, v227
    v_dot2_f32_bf16 v220, v204, v17, 0
    v_dot2_f32_bf16 v221, v205, v19, 0
    v_dot2_f32_bf16 v222, v206, v21, 0
    v_dot2_f32_bf16 v223, v207, v23, 0
    v_dot2_f32_bf16 v224, v208, v25, 0
    v_dot2_f32_bf16 v225, v209, v27, 0
    v_dot2_f32_bf16 v226, v210, v29, 0
    v_dot2_f32_bf16 v227, v211, v31, 0
    buffer_load_dwordx4 v[168:171], v11, s[36:39], 0 offen offset:2688
    s_waitcnt vmcnt(14)
    v_lshlrev_b32 v236, 16, v140
    v_and_b32 v237, s61, v140
    v_pk_mul_f32 v[240:241], v[240:241], v[236:237]
    v_lshlrev_b32 v238, 16, v141
    v_and_b32 v239, s61, v141
    v_pk_mul_f32 v[242:243], v[242:243], v[238:239]
    v_lshlrev_b32 v236, 16, v142
    v_and_b32 v237, s61, v142
    v_pk_mul_f32 v[244:245], v[244:245], v[236:237]
    v_lshlrev_b32 v238, 16, v143
    v_and_b32 v239, s61, v143
    v_pk_mul_f32 v[246:247], v[246:247], v[238:239]
    s_waitcnt vmcnt(13)
    v_perm_b32 v204, v76, v80, s64
    v_perm_b32 v205, v76, v80, s65
    v_perm_b32 v206, v77, v81, s64
    v_perm_b32 v207, v77, v81, s65
    v_perm_b32 v208, v78, v82, s64
    v_perm_b32 v209, v78, v82, s65
    v_perm_b32 v210, v79, v83, s64
    v_perm_b32 v211, v79, v83, s65
    v_dot2_f32_bf16 v248, v204, v16, v212
    v_dot2_f32_bf16 v249, v205, v18, v213
    v_dot2_f32_bf16 v250, v206, v20, v214
    v_dot2_f32_bf16 v251, v207, v22, v215
    v_dot2_f32_bf16 v252, v208, v24, v216
    v_dot2_f32_bf16 v253, v209, v26, v217
    v_dot2_f32_bf16 v254, v210, v28, v218
    v_dot2_f32_bf16 v255, v211, v30, v219
    v_dot2_f32_bf16 v212, v204, v17, 0
    v_dot2_f32_bf16 v213, v205, v19, 0
    v_dot2_f32_bf16 v214, v206, v21, 0
    v_dot2_f32_bf16 v215, v207, v23, 0
    v_dot2_f32_bf16 v216, v208, v25, 0
    v_dot2_f32_bf16 v217, v209, v27, 0
    v_dot2_f32_bf16 v218, v210, v29, 0
    v_dot2_f32_bf16 v219, v211, v31, 0
    s_waitcnt vmcnt(12)
    v_lshlrev_b32 v236, 16, v144
    v_and_b32 v237, s61, v144
    v_pk_mul_f32 v[248:249], v[248:249], v[236:237]
    v_lshlrev_b32 v238, 16, v145
    v_and_b32 v239, s61, v145
    v_pk_mul_f32 v[250:251], v[250:251], v[238:239]
    v_lshlrev_b32 v236, 16, v146
    v_and_b32 v237, s61, v146
    v_pk_mul_f32 v[252:253], v[252:253], v[236:237]
    v_lshlrev_b32 v238, 16, v147
    v_and_b32 v239, s61, v147
    v_pk_mul_f32 v[254:255], v[254:255], v[238:239]
    v_cvt_pk_bf16_f32 v175, v248, v240
    v_cvt_pk_bf16_f32 v179, v249, v241
    v_cvt_pk_bf16_f32 v183, v250, v242
    v_cvt_pk_bf16_f32 v187, v251, v243
    v_cvt_pk_bf16_f32 v191, v252, v244
    v_cvt_pk_bf16_f32 v195, v253, v245
    v_cvt_pk_bf16_f32 v199, v254, v246
    v_cvt_pk_bf16_f32 v203, v255, v247
    s_waitcnt vmcnt(11)
    v_perm_b32 v204, v80, v84, s64
    v_perm_b32 v205, v80, v84, s65
    v_perm_b32 v206, v81, v85, s64
    v_perm_b32 v207, v81, v85, s65
    v_perm_b32 v208, v82, v86, s64
    v_perm_b32 v209, v82, v86, s65
    v_perm_b32 v210, v83, v87, s64
    v_perm_b32 v211, v83, v87, s65
    v_dot2_f32_bf16 v240, v204, v16, v220
    v_dot2_f32_bf16 v241, v205, v18, v221
    v_dot2_f32_bf16 v242, v206, v20, v222
    v_dot2_f32_bf16 v243, v207, v22, v223
    v_dot2_f32_bf16 v244, v208, v24, v224
    v_dot2_f32_bf16 v245, v209, v26, v225
    v_dot2_f32_bf16 v246, v210, v28, v226
    v_dot2_f32_bf16 v247, v211, v30, v227
    v_dot2_f32_bf16 v220, v204, v17, 0
    v_dot2_f32_bf16 v221, v205, v19, 0
    v_dot2_f32_bf16 v222, v206, v21, 0
    v_dot2_f32_bf16 v223, v207, v23, 0
    v_dot2_f32_bf16 v224, v208, v25, 0
    v_dot2_f32_bf16 v225, v209, v27, 0
    v_dot2_f32_bf16 v226, v210, v29, 0
    v_dot2_f32_bf16 v227, v211, v31, 0
    s_waitcnt vmcnt(10)
    v_lshlrev_b32 v236, 16, v148
    v_and_b32 v237, s61, v148
    v_pk_mul_f32 v[240:241], v[240:241], v[236:237]
    v_lshlrev_b32 v238, 16, v149
    v_and_b32 v239, s61, v149
    v_pk_mul_f32 v[242:243], v[242:243], v[238:239]
    v_lshlrev_b32 v236, 16, v150
    v_and_b32 v237, s61, v150
    v_pk_mul_f32 v[244:245], v[244:245], v[236:237]
    v_lshlrev_b32 v238, 16, v151
    v_and_b32 v239, s61, v151
    v_pk_mul_f32 v[246:247], v[246:247], v[238:239]
    s_waitcnt vmcnt(9)
    v_perm_b32 v204, v84, v88, s64
    v_perm_b32 v205, v84, v88, s65
    v_perm_b32 v206, v85, v89, s64
    v_perm_b32 v207, v85, v89, s65
    v_perm_b32 v208, v86, v90, s64
    v_perm_b32 v209, v86, v90, s65
    v_perm_b32 v210, v87, v91, s64
    v_perm_b32 v211, v87, v91, s65
    v_dot2_f32_bf16 v248, v204, v16, v212
    v_dot2_f32_bf16 v249, v205, v18, v213
    v_dot2_f32_bf16 v250, v206, v20, v214
    v_dot2_f32_bf16 v251, v207, v22, v215
    v_dot2_f32_bf16 v252, v208, v24, v216
    v_dot2_f32_bf16 v253, v209, v26, v217
    v_dot2_f32_bf16 v254, v210, v28, v218
    v_dot2_f32_bf16 v255, v211, v30, v219
    v_dot2_f32_bf16 v212, v204, v17, 0
    v_dot2_f32_bf16 v213, v205, v19, 0
    v_dot2_f32_bf16 v214, v206, v21, 0
    v_dot2_f32_bf16 v215, v207, v23, 0
    v_dot2_f32_bf16 v216, v208, v25, 0
    v_dot2_f32_bf16 v217, v209, v27, 0
    v_dot2_f32_bf16 v218, v210, v29, 0
    v_dot2_f32_bf16 v219, v211, v31, 0
    s_waitcnt vmcnt(8)
    v_lshlrev_b32 v236, 16, v152
    v_and_b32 v237, s61, v152
    v_pk_mul_f32 v[248:249], v[248:249], v[236:237]
    v_lshlrev_b32 v238, 16, v153
    v_and_b32 v239, s61, v153
    v_pk_mul_f32 v[250:251], v[250:251], v[238:239]
    v_lshlrev_b32 v236, 16, v154
    v_and_b32 v237, s61, v154
    v_pk_mul_f32 v[252:253], v[252:253], v[236:237]
    v_lshlrev_b32 v238, 16, v155
    v_and_b32 v239, s61, v155
    v_pk_mul_f32 v[254:255], v[254:255], v[238:239]
    v_cvt_pk_bf16_f32 v174, v248, v240
    v_cvt_pk_bf16_f32 v178, v249, v241
    v_cvt_pk_bf16_f32 v182, v250, v242
    v_cvt_pk_bf16_f32 v186, v251, v243
    v_cvt_pk_bf16_f32 v190, v252, v244
    v_cvt_pk_bf16_f32 v194, v253, v245
    v_cvt_pk_bf16_f32 v198, v254, v246
    v_cvt_pk_bf16_f32 v202, v255, v247
    s_waitcnt vmcnt(7)
    v_perm_b32 v204, v88, v92, s64
    v_perm_b32 v205, v88, v92, s65
    v_perm_b32 v206, v89, v93, s64
    v_perm_b32 v207, v89, v93, s65
    v_perm_b32 v208, v90, v94, s64
    v_perm_b32 v209, v90, v94, s65
    v_perm_b32 v210, v91, v95, s64
    v_perm_b32 v211, v91, v95, s65
    v_dot2_f32_bf16 v240, v204, v16, v220
    v_dot2_f32_bf16 v241, v205, v18, v221
    v_dot2_f32_bf16 v242, v206, v20, v222
    v_dot2_f32_bf16 v243, v207, v22, v223
    v_dot2_f32_bf16 v244, v208, v24, v224
    v_dot2_f32_bf16 v245, v209, v26, v225
    v_dot2_f32_bf16 v246, v210, v28, v226
    v_dot2_f32_bf16 v247, v211, v30, v227
    v_dot2_f32_bf16 v220, v204, v17, 0
    v_dot2_f32_bf16 v221, v205, v19, 0
    v_dot2_f32_bf16 v222, v206, v21, 0
    v_dot2_f32_bf16 v223, v207, v23, 0
    v_dot2_f32_bf16 v224, v208, v25, 0
    v_dot2_f32_bf16 v225, v209, v27, 0
    v_dot2_f32_bf16 v226, v210, v29, 0
    v_dot2_f32_bf16 v227, v211, v31, 0
    s_waitcnt vmcnt(6)
    v_lshlrev_b32 v236, 16, v156
    v_and_b32 v237, s61, v156
    v_pk_mul_f32 v[240:241], v[240:241], v[236:237]
    v_lshlrev_b32 v238, 16, v157
    v_and_b32 v239, s61, v157
    v_pk_mul_f32 v[242:243], v[242:243], v[238:239]
    v_lshlrev_b32 v236, 16, v158
    v_and_b32 v237, s61, v158
    v_pk_mul_f32 v[244:245], v[244:245], v[236:237]
    v_lshlrev_b32 v238, 16, v159
    v_and_b32 v239, s61, v159
    v_pk_mul_f32 v[246:247], v[246:247], v[238:239]
    s_waitcnt vmcnt(5)
    v_perm_b32 v204, v92, v96, s64
    v_perm_b32 v205, v92, v96, s65
    v_perm_b32 v206, v93, v97, s64
    v_perm_b32 v207, v93, v97, s65
    v_perm_b32 v208, v94, v98, s64
    v_perm_b32 v209, v94, v98, s65
    v_perm_b32 v210, v95, v99, s64
    v_perm_b32 v211, v95, v99, s65
    v_dot2_f32_bf16 v248, v204, v16, v212
    v_dot2_f32_bf16 v249, v205, v18, v213
    v_dot2_f32_bf16 v250, v206, v20, v214
    v_dot2_f32_bf16 v251, v207, v22, v215
    v_dot2_f32_bf16 v252, v208, v24, v216
    v_dot2_f32_bf16 v253, v209, v26, v217
    v_dot2_f32_bf16 v254, v210, v28, v218
    v_dot2_f32_bf16 v255, v211, v30, v219
    v_dot2_f32_bf16 v212, v204, v17, 0
    v_dot2_f32_bf16 v213, v205, v19, 0
    v_dot2_f32_bf16 v214, v206, v21, 0
    v_dot2_f32_bf16 v215, v207, v23, 0
    v_dot2_f32_bf16 v216, v208, v25, 0
    v_dot2_f32_bf16 v217, v209, v27, 0
    v_dot2_f32_bf16 v218, v210, v29, 0
    v_dot2_f32_bf16 v219, v211, v31, 0
    s_waitcnt vmcnt(4)
    v_lshlrev_b32 v236, 16, v160
    v_and_b32 v237, s61, v160
    v_pk_mul_f32 v[248:249], v[248:249], v[236:237]
    v_lshlrev_b32 v238, 16, v161
    v_and_b32 v239, s61, v161
    v_pk_mul_f32 v[250:251], v[250:251], v[238:239]
    v_lshlrev_b32 v236, 16, v162
    v_and_b32 v237, s61, v162
    v_pk_mul_f32 v[252:253], v[252:253], v[236:237]
    v_lshlrev_b32 v238, 16, v163
    v_and_b32 v239, s61, v163
    v_pk_mul_f32 v[254:255], v[254:255], v[238:239]
    v_cvt_pk_bf16_f32 v173, v248, v240
    v_cvt_pk_bf16_f32 v177, v249, v241
    v_cvt_pk_bf16_f32 v181, v250, v242
    v_cvt_pk_bf16_f32 v185, v251, v243
    v_cvt_pk_bf16_f32 v189, v252, v244
    v_cvt_pk_bf16_f32 v193, v253, v245
    v_cvt_pk_bf16_f32 v197, v254, v246
    v_cvt_pk_bf16_f32 v201, v255, v247
    s_waitcnt vmcnt(3)
    v_perm_b32 v204, v96, v100, s64
    v_perm_b32 v205, v96, v100, s65
    v_perm_b32 v206, v97, v101, s64
    v_perm_b32 v207, v97, v101, s65
    v_perm_b32 v208, v98, v102, s64
    v_perm_b32 v209, v98, v102, s65
    v_perm_b32 v210, v99, v103, s64
    v_perm_b32 v211, v99, v103, s65
    v_dot2_f32_bf16 v240, v204, v16, v220
    v_dot2_f32_bf16 v241, v205, v18, v221
    v_dot2_f32_bf16 v242, v206, v20, v222
    v_dot2_f32_bf16 v243, v207, v22, v223
    v_dot2_f32_bf16 v244, v208, v24, v224
    v_dot2_f32_bf16 v245, v209, v26, v225
    v_dot2_f32_bf16 v246, v210, v28, v226
    v_dot2_f32_bf16 v247, v211, v30, v227
    s_waitcnt vmcnt(2)
    v_lshlrev_b32 v236, 16, v164
    v_and_b32 v237, s61, v164
    v_pk_mul_f32 v[240:241], v[240:241], v[236:237]
    v_lshlrev_b32 v238, 16, v165
    v_and_b32 v239, s61, v165
    v_pk_mul_f32 v[242:243], v[242:243], v[238:239]
    v_lshlrev_b32 v236, 16, v166
    v_and_b32 v237, s61, v166
    v_pk_mul_f32 v[244:245], v[244:245], v[236:237]
    v_lshlrev_b32 v238, 16, v167
    v_and_b32 v239, s61, v167
    v_pk_mul_f32 v[246:247], v[246:247], v[238:239]
    s_waitcnt vmcnt(1)
    v_perm_b32 v204, v100, v104, s64
    v_perm_b32 v205, v100, v104, s65
    v_perm_b32 v206, v101, v105, s64
    v_perm_b32 v207, v101, v105, s65
    v_perm_b32 v208, v102, v106, s64
    v_perm_b32 v209, v102, v106, s65
    v_perm_b32 v210, v103, v107, s64
    v_perm_b32 v211, v103, v107, s65
    v_dot2_f32_bf16 v248, v204, v16, v212
    v_dot2_f32_bf16 v249, v205, v18, v213
    v_dot2_f32_bf16 v250, v206, v20, v214
    v_dot2_f32_bf16 v251, v207, v22, v215
    v_dot2_f32_bf16 v252, v208, v24, v216
    v_dot2_f32_bf16 v253, v209, v26, v217
    v_dot2_f32_bf16 v254, v210, v28, v218
    v_dot2_f32_bf16 v255, v211, v30, v219
    s_waitcnt vmcnt(0)
    v_lshlrev_b32 v236, 16, v168
    v_and_b32 v237, s61, v168
    v_pk_mul_f32 v[248:249], v[248:249], v[236:237]
    v_lshlrev_b32 v238, 16, v169
    v_and_b32 v239, s61, v169
    v_pk_mul_f32 v[250:251], v[250:251], v[238:239]
    v_lshlrev_b32 v236, 16, v170
    v_and_b32 v237, s61, v170
    v_pk_mul_f32 v[252:253], v[252:253], v[236:237]
    v_lshlrev_b32 v238, 16, v171
    v_and_b32 v239, s61, v171
    v_pk_mul_f32 v[254:255], v[254:255], v[238:239]
    v_cvt_pk_bf16_f32 v172, v248, v240
    v_cvt_pk_bf16_f32 v176, v249, v241
    v_cvt_pk_bf16_f32 v180, v250, v242
    v_cvt_pk_bf16_f32 v184, v251, v243
    v_cvt_pk_bf16_f32 v188, v252, v244
    v_cvt_pk_bf16_f32 v192, v253, v245
    v_cvt_pk_bf16_f32 v196, v254, v246
    v_cvt_pk_bf16_f32 v200, v255, v247
    ds_write_b128 v5, v[172:175] offset:0
    ds_write_b128 v5, v[176:179] offset:128
    ds_write_b128 v5, v[180:183] offset:256
    ds_write_b128 v5, v[184:187] offset:384
    ds_write_b128 v5, v[188:191] offset:512
    ds_write_b128 v5, v[192:195] offset:640
    ds_write_b128 v5, v[196:199] offset:768
    ds_write_b128 v5, v[200:203] offset:896
    v_lshrrev_b32 v10, 3, v1
    v_lshlrev_b32 v11, 12, v10
    v_lshl_add_u32 v11, v4, 4, v11
    s_mul_i32 s95, s88, 14
    s_lshl_b32 s96, s60, 7
    s_sub_u32 s96, 8392576, s96
    s_lshl_b32 s97, s95, 15
    s_add_u32 s96, s96, s97
    s_lshl_b32 s97, s95, 10
    v_lshl_add_u32 v10, v10, 7, s97
    s_waitcnt lgkmcnt(0)
    s_barrier
    s_add_u32 s97, s95, 0
    s_and_b32 s97, s97, 7
    v_xor_b32 v12, s97, v4
    v_lshl_add_u32 v12, v12, 4, v10
    ds_read_b128 v[32:35], v12 offset:0
    s_add_u32 s97, s95, 1
    s_and_b32 s97, s97, 7
    v_xor_b32 v12, s97, v4
    v_lshl_add_u32 v12, v12, 4, v10
    ds_read_b128 v[36:39], v12 offset:1024
    s_add_u32 s97, s95, 2
    s_and_b32 s97, s97, 7
    v_xor_b32 v12, s97, v4
    v_lshl_add_u32 v12, v12, 4, v10
    ds_read_b128 v[40:43], v12 offset:2048
    s_add_u32 s97, s95, 3
    s_and_b32 s97, s97, 7
    v_xor_b32 v12, s97, v4
    v_lshl_add_u32 v12, v12, 4, v10
    ds_read_b128 v[44:47], v12 offset:3072
    s_add_u32 s97, s95, 4
    s_and_b32 s97, s97, 7
    v_xor_b32 v12, s97, v4
    v_lshl_add_u32 v12, v12, 4, v10
    ds_read_b128 v[48:51], v12 offset:4096
    s_add_u32 s97, s95, 5
    s_and_b32 s97, s97, 7
    v_xor_b32 v12, s97, v4
    v_lshl_add_u32 v12, v12, 4, v10
    ds_read_b128 v[52:55], v12 offset:5120
    s_add_u32 s97, s95, 6
    s_and_b32 s97, s97, 7
    v_xor_b32 v12, s97, v4
    v_lshl_add_u32 v12, v12, 4, v10
    ds_read_b128 v[56:59], v12 offset:6144
    s_add_u32 s97, s95, 7
    s_and_b32 s97, s97, 7
    v_xor_b32 v12, s97, v4
    v_lshl_add_u32 v12, v12, 4, v10
    ds_read_b128 v[60:63], v12 offset:7168
    s_add_u32 s97, s95, 8
    s_and_b32 s97, s97, 7
    v_xor_b32 v12, s97, v4
    v_lshl_add_u32 v12, v12, 4, v10
    ds_read_b128 v[64:67], v12 offset:8192
    s_add_u32 s97, s95, 9
    s_and_b32 s97, s97, 7
    v_xor_b32 v12, s97, v4
    v_lshl_add_u32 v12, v12, 4, v10
    ds_read_b128 v[68:71], v12 offset:9216
    s_add_u32 s97, s95, 10
    s_and_b32 s97, s97, 7
    v_xor_b32 v12, s97, v4
    v_lshl_add_u32 v12, v12, 4, v10
    ds_read_b128 v[72:75], v12 offset:10240
    s_add_u32 s97, s95, 11
    s_and_b32 s97, s97, 7
    v_xor_b32 v12, s97, v4
    v_lshl_add_u32 v12, v12, 4, v10
    ds_read_b128 v[76:79], v12 offset:11264
    s_add_u32 s97, s95, 12
    s_and_b32 s97, s97, 7
    v_xor_b32 v12, s97, v4
    v_lshl_add_u32 v12, v12, 4, v10
    ds_read_b128 v[80:83], v12 offset:12288
    s_add_u32 s97, s95, 13
    s_and_b32 s97, s97, 7
    v_xor_b32 v12, s97, v4
    v_lshl_add_u32 v12, v12, 4, v10
    ds_read_b128 v[84:87], v12 offset:13312
    s_waitcnt lgkmcnt(13)
    buffer_store_dwordx4 v[32:35], v11, s[44:47], s96 offen sc1
    s_add_u32 s96, s96, 32768
    s_waitcnt lgkmcnt(12)
    buffer_store_dwordx4 v[36:39], v11, s[44:47], s96 offen sc1
    s_add_u32 s96, s96, 32768
    s_waitcnt lgkmcnt(11)
    buffer_store_dwordx4 v[40:43], v11, s[44:47], s96 offen sc1
    s_add_u32 s96, s96, 32768
    s_waitcnt lgkmcnt(10)
    buffer_store_dwordx4 v[44:47], v11, s[44:47], s96 offen sc1
    s_add_u32 s96, s96, 32768
    s_waitcnt lgkmcnt(9)
    buffer_store_dwordx4 v[48:51], v11, s[44:47], s96 offen sc1
    s_add_u32 s96, s96, 32768
    s_waitcnt lgkmcnt(8)
    buffer_store_dwordx4 v[52:55], v11, s[44:47], s96 offen sc1
    s_add_u32 s96, s96, 32768
    s_waitcnt lgkmcnt(7)
    buffer_store_dwordx4 v[56:59], v11, s[44:47], s96 offen sc1
    s_add_u32 s96, s96, 32768
    s_waitcnt lgkmcnt(6)
    buffer_store_dwordx4 v[60:63], v11, s[44:47], s96 offen sc1
    s_add_u32 s96, s96, 32768
    s_waitcnt lgkmcnt(5)
    buffer_store_dwordx4 v[64:67], v11, s[44:47], s96 offen sc1
    s_add_u32 s96, s96, 32768
    s_waitcnt lgkmcnt(4)
    buffer_store_dwordx4 v[68:71], v11, s[44:47], s96 offen sc1
    s_add_u32 s96, s96, 32768
    s_waitcnt lgkmcnt(3)
    buffer_store_dwordx4 v[72:75], v11, s[44:47], s96 offen sc1
    s_add_u32 s96, s96, 32768
    s_waitcnt lgkmcnt(2)
    buffer_store_dwordx4 v[76:79], v11, s[44:47], s96 offen sc1
    s_add_u32 s96, s96, 32768
    s_waitcnt lgkmcnt(1)
    buffer_store_dwordx4 v[80:83], v11, s[44:47], s96 offen sc1
    s_add_u32 s96, s96, 32768
    s_waitcnt lgkmcnt(0)
    buffer_store_dwordx4 v[84:87], v11, s[44:47], s96 offen sc1
    s_add_u32 s96, s96, 32768
    s_lshl2_add_u32 s95, s60, 128
    s_cmp_eq_u32 s88, 0
    s_cselect_b32 s95, s95, 2130706432
    v_mov_b32 v2, 2130706432
    v_writelane_b32 v2, s95, 0
    s_lshl2_add_u32 s95, s60, s88
    s_mul_i32 s95, s95, 14336
    s_add_u32 s95, s95, 10485760
    v_lshlrev_b32 v3, 4, v1
    v_mov_b32 v240, -1
    v_mov_b32 v241, -1
    v_mov_b32 v242, -1
    v_mov_b32 v243, -1
    v_mov_b32 v8, 1
    s_waitcnt vmcnt(0)
    s_barrier
    buffer_store_dword v8, v2, s[56:59], 0 offen sc1
    buffer_store_dwordx4 v[240:243], v3, s[44:47], s95 offen offset:0 sc1
    buffer_store_dwordx4 v[240:243], v3, s[44:47], s95 offen offset:1024 sc1
    s_add_u32 s95, s95, 2048
    buffer_store_dwordx4 v[240:243], v3, s[44:47], s95 offen offset:0 sc1
    buffer_store_dwordx4 v[240:243], v3, s[44:47], s95 offen offset:1024 sc1
    s_add_u32 s95, s95, 2048
    buffer_store_dwordx4 v[240:243], v3, s[44:47], s95 offen offset:0 sc1
    buffer_store_dwordx4 v[240:243], v3, s[44:47], s95 offen offset:1024 sc1
    s_add_u32 s95, s95, 2048
    buffer_store_dwordx4 v[240:243], v3, s[44:47], s95 offen offset:0 sc1
    buffer_store_dwordx4 v[240:243], v3, s[44:47], s95 offen offset:1024 sc1
    s_add_u32 s95, s95, 2048
    buffer_store_dwordx4 v[240:243], v3, s[44:47], s95 offen offset:0 sc1
    buffer_store_dwordx4 v[240:243], v3, s[44:47], s95 offen offset:1024 sc1
    s_add_u32 s95, s95, 2048
    buffer_store_dwordx4 v[240:243], v3, s[44:47], s95 offen offset:0 sc1
    buffer_store_dwordx4 v[240:243], v3, s[44:47], s95 offen offset:1024 sc1
    s_add_u32 s95, s95, 2048
    buffer_store_dwordx4 v[240:243], v3, s[44:47], s95 offen offset:0 sc1
    buffer_store_dwordx4 v[240:243], v3, s[44:47], s95 offen offset:1024 sc1
    s_add_u32 s95, s95, 2048
    s_waitcnt vmcnt(0)
    s_barrier
    buffer_store_dword v7, v2, s[56:59], 0 offen sc1
    s_endpgm
L_slow0:
    s_mov_b32 s100, 0x20000
L_slowl0:
    buffer_load_dword v6, v29, s[56:59], 0 offen sc1
    s_waitcnt vmcnt(0)
    v_cmp_gt_u32 vcc, s4, v6
    s_nop 4
    s_cbranch_vccz L_back0
    s_sleep 1
    s_sub_u32 s100, s100, 1
    s_cmp_lg_u32 s100, 0
    s_cbranch_scc1 L_slowl0
    s_branch L_back0
L_slow1:
    s_mov_b32 s100, 0x20000
L_slowl1:
    buffer_load_dword v254, v5, s[44:47], 0 offen sc1
    s_waitcnt vmcnt(0)
    v_cmp_gt_u32 vcc, s4, v254
    s_nop 4
    s_cbranch_vccz L_back1
    s_sleep 1
    s_sub_u32 s100, s100, 1
    s_cmp_lg_u32 s100, 0
    s_cbranch_scc1 L_slowl1
    s_branch L_back1
L_slow2:
    s_mov_b32 s100, 0x20000
L_slowl2:
    buffer_load_dword v4, v5, s[44:47], s14 offen sc1
    s_waitcnt vmcnt(0)
    v_cmp_gt_u32 vcc, s4, v4
    s_nop 4
    s_cbranch_vccz L_back2
    s_sleep 1
    s_sub_u32 s100, s100, 1
    s_cmp_lg_u32 s100, 0
    s_cbranch_scc1 L_slowl2
    s_branch L_back2
L_slow3:
    s_mov_b32 s100, 0x20000
L_slowl3:
    buffer_load_dword v3, v29, s[56:59], 0 offen sc1
    s_waitcnt vmcnt(0)
    v_cmp_gt_u32 vcc, s5, v3
    s_nop 4
    s_cbranch_vccz L_back3
    s_sleep 1
    s_sub_u32 s100, s100, 1
    s_cmp_lg_u32 s100, 0
    s_cbranch_scc1 L_slowl3
    s_branch L_back3
L_slow4:
    s_mov_b32 s100, 0x20000
L_slowl4:
    buffer_load_dwordx4 v[224:227], v235, s[44:47], s92 offen sc1
    buffer_load_dwordx4 v[228:231], v236, s[44:47], s92 offen sc1
    s_waitcnt vmcnt(0)
    v_max3_u32 v238, v224, v226, v228
    v_max_u32 v238, v238, v230
    v_cmp_eq_u32 vcc, -1, v238
    s_nop 4
    s_cbranch_vccz L_back4
    s_sleep 1
    s_sub_u32 s100, s100, 1
    s_cmp_lg_u32 s100, 0
    s_cbranch_scc1 L_slowl4
    s_branch L_back4
L_exit:
    s_endpgm
.section .rodata,"a"
.p2align 6
.amdhsa_kernel recurrent_scan__ssm_conv_h3__glu_gated_geglu__prompt_kernel
  .amdhsa_next_free_vgpr 512
  .amdhsa_next_free_sgpr 102
  .amdhsa_accum_offset 256
  .amdhsa_group_segment_fixed_size 0
  .amdhsa_kernarg_size 104
  .amdhsa_user_sgpr_count 2
  .amdhsa_user_sgpr_kernarg_segment_ptr 1
  .amdhsa_system_sgpr_workgroup_id_x 1
  .amdhsa_float_denorm_mode_32 3
.end_amdhsa_kernel
```
